```python
import torch

def _softmax(x, axis=-1):
    return torch.softmax(x, dim=axis)
def _gelu(x):
    return torch.nn.functional.gelu(x, approximate="tanh")
def _silu(x):
    return torch.nn.functional.silu(x)
def _sigmoid(x):
    return torch.sigmoid(x)
def _layernorm(x, axis=-1, eps=1e-5):
    m = x.mean(dim=axis, keepdim=True)
    v = x.var(dim=axis, keepdim=True, unbiased=False)
    return (x - m) / torch.sqrt(v + eps)
def _scatter_add(tgt, idx, src, axis=0):
    return tgt.clone().index_add_(axis, idx, src)
def _segment_sum(src, seg, n):
    out = torch.zeros((n,) + src.shape[1:], dtype=src.dtype)
    return out.index_add_(0, seg, src)
def _pad(x, pw):
    flat = tuple(v for pair in reversed(pw) for v in pair)
    return torch.nn.functional.pad(x, flat)

kernel_name = 'gather_scatter__edge_featured_mpnn_mpnn__graph'

def setup_inputs():

    _w = (lambda a: (lambda t: t.to(torch.bfloat16) if t.is_floating_point() else t)(torch.as_tensor(a)))
    N, deg, D, De = 10000, 64, 64, max(16, 1)
    E = N * deg
    H = 2 * D
    return {
        "x": _w((lambda *s: torch.randn(*s, dtype=torch.bfloat16) * 0.05)(N, D)),
        "e_attr": _w((lambda *s: torch.randn(*s, dtype=torch.bfloat16) * 0.8)(E, De)),
        "src": _w((lambda lo, hi, *s: torch.randint(lo, hi, s))(0, N, E).to(torch.int64)),
        "dst": _w((lambda lo, hi, *s: torch.randint(lo, hi, s))(0, N, E).to(torch.int64)),
        "w1": _w((lambda *s: torch.randn(*s, dtype=torch.bfloat16) * 0.8)(2 * D + De, H) * (1.0 / (2 * D + De) ** 0.5)),
        "b1": _w((lambda *s: torch.randn(*s, dtype=torch.bfloat16) * 0.4)(H) * 0.01),
        "w2": _w((lambda *s: torch.randn(*s, dtype=torch.bfloat16) * 0.05)(H, D) * (1.0 / H ** 0.5)),
        "b2": _w((lambda *s: torch.randn(*s, dtype=torch.bfloat16) * 0.05)(D) * 0.01),
    }

def reference(x, e_attr, src, dst, w1, b1, w2, b2):
    N, D = x.shape
    h_src = x[src]
    h_dst = x[dst]
    m_in = torch.concatenate([h_src, h_dst, e_attr], axis=-1)
    h = _silu(m_in @ w1 + b1)
    msg = h @ w2 + b2
    return _segment_sum(msg, dst, N)
```

```asm
; @launch grid=(256,1,1) block=(512,1,1) lds=161792
.amdgcn_target "amdgcn-amd-amdhsa--gfx950"
.text
.globl gather_scatter__edge_featured_mpnn_mpnn__graph_kernel
.p2align 8
.type gather_scatter__edge_featured_mpnn_mpnn__graph_kernel,@function
gather_scatter__edge_featured_mpnn_mpnn__graph_kernel:
    s_cmp_ge_u32 s2, 256
    s_cbranch_scc1 k_end
    s_load_dwordx16 s[48:63], s[0:1], 0
    s_load_dwordx4 s[64:67], s[0:1], 64
    s_load_dwordx2 s[46:47], s[0:1], 80
    v_and_b32 v1, 63, v0
    v_lshrrev_b32 v2, 6, v0
    s_mul_i32 s43, s2, 625
    v_readfirstlane_b32 s42, v2
    v_lshlrev_b32 v241, 4, v0
    v_mov_b32 v212, 0
    v_mov_b32 v213, 0
    v_mov_b32 v214, 0
    v_mov_b32 v215, 0
    v_cmp_gt_u32 vcc, 68, v0
    s_and_saveexec_b64 s[98:99], vcc
    ds_write_b128 v241, v[212:215] offset:0
    s_mov_b64 exec, s[98:99]
    v_lshlrev_b32 v243, 4, v0
    v_add_u32 v243, 102400, v243
    v_cmp_gt_u32 vcc, 64, v0
    s_and_saveexec_b64 s[98:99], vcc
    ds_write_b128 v243, v[212:215] offset:0
    s_mov_b64 exec, s[98:99]
    s_add_u32 s44, s43, 640
    s_add_u32 s43, s43, 15
    s_lshr_b32 s43, s43, 4
    s_lshr_b32 s44, s44, 4
    s_sub_u32 s44, s44, s43
    v_lshrrev_b32 v2, 3, v1
    v_and_b32 v3, 7, v1
    v_and_b32 v4, 31, v1
    v_lshrrev_b32 v5, 5, v1
    s_waitcnt lgkmcnt(0)
    s_mov_b32 s36, s54
    s_and_b32 s37, s55, 0xffff
    s_mov_b32 s38, 2560000
    s_mov_b32 s39, 0x20000
    s_mov_b32 s32, s52
    s_and_b32 s33, s53, 0xffff
    s_mov_b32 s34, 2560000
    s_mov_b32 s35, 0x20000
    s_mul_i32 s90, s2, 10000
    v_lshlrev_b32 v6, 4, v0
    v_add_u32 v6, s90, v6
    buffer_load_dwordx4 v[16:19], v6, s[36:39], 0 offen
    buffer_load_dwordx4 v[20:23], v6, s[32:35], 0 offen
    s_add_u32 s91, s90, 8192
    v_lshlrev_b32 v7, 2, v0
    v_cmp_gt_u32 vcc, 452, v0
    s_and_saveexec_b64 s[96:97], vcc
    buffer_load_dword v24, v7, s[36:39], s91 offen
    buffer_load_dword v28, v7, s[32:35], s91 offen
    s_mov_b64 exec, s[96:97]
    v_mov_b32 v85, 0x7fffff00
    s_cmp_eq_u32 s42, 7
    s_cbranch_scc0 pa_now
    s_cmp_lt_u32 s2, 144
    s_cbranch_scc0 pa_now
    s_and_b32 s90, s2, 3
    s_lshl_b32 s90, s90, 6
    v_add_u32 v76, s90, v1
    v_lshrrev_b32 v77, 2, v76
    v_and_b32 v78, 3, v76
    v_and_b32 v79, 31, v77
    v_lshrrev_b32 v80, 5, v77
    v_lshlrev_b32 v81, 3, v80
    v_lshl_add_u32 v81, v78, 1, v81
    s_cmp_lt_u32 s2, 80
    s_cbranch_scc1 pa_w_main
    s_sub_u32 s91, s2, 80
    s_lshr_b32 s91, s91, 2
    s_add_u32 s92, s91, 20
    s_lshr_b32 s93, s91, 3
    s_and_b32 s94, s91, 7
    s_lshl_b32 s94, s94, 4
    s_lshl_b32 s93, s93, 5
    s_mov_b32 s68, s60
    s_and_b32 s69, s61, 0xffff
    s_mov_b32 s70, 16384
    s_mov_b32 s71, 0x20000
    s_movk_i32 s95, 128
    s_mov_b32 s89, 0
    s_branch pa_w_go
pa_w_main:
    s_lshr_b32 s92, s2, 2
    s_mul_i32 s93, s92, 13
    s_lshr_b32 s93, s93, 6
    s_mul_i32 s94, s93, 5
    s_sub_u32 s94, s92, s94
    s_cmp_eq_u32 s94, 4
    s_cselect_b32 s94, 8, s94
    s_lshl_b32 s94, s94, 4
    s_lshl_b32 s93, s93, 5
    s_mov_b32 s68, s56
    s_and_b32 s69, s57, 0xffff
    s_mov_b32 s70, 36864
    s_mov_b32 s71, 0x20000
    s_movk_i32 s95, 256
    s_mov_b32 s89, 1
pa_w_go:
    v_add_u32 v81, s94, v81
    v_add_u32 v79, s93, v79
    v_mul_lo_u32 v81, v81, s95
    v_lshl_add_u32 v81, v79, 1, v81
    v_add_u32 v82, s95, v81
    buffer_load_ushort v83, v81, s[68:71], 0 offen
    buffer_load_ushort v84, v82, s[68:71], 0 offen
    s_lshl_b32 s92, s92, 10
    v_lshl_add_u32 v85, v76, 2, s92
pa_now:
    s_barrier
    s_sub_u32 s4, s48, 3120
    s_subb_u32 s5, s49, 0
    s_and_b32 s5, s5, 0xffff
    s_mov_b32 s6, 1283120
    s_mov_b32 s7, 0x20000
    s_mov_b32 s72, s66
    s_and_b32 s73, s67, 0xffff
    s_mov_b32 s74, 256
    s_mov_b32 s75, 0x20000
    s_mov_b32 s24, s58
    s_and_b32 s25, s59, 0xffff
    s_mov_b32 s26, 256
    s_mov_b32 s27, 0x20000
    s_mov_b32 s28, s56
    s_and_b32 s29, s57, 0xffff
    s_mov_b32 s30, 36864
    s_mov_b32 s31, 0x20000
    s_movk_i32 s83, 3120
    s_movk_i32 s84, 2080
    s_movk_i32 s85, 1040
    s_cmp_eq_u32 s2, 0
    s_cbranch_scc0 k_notag
    s_cmp_eq_u32 s42, 6
    s_cbranch_scc0 k_notag
    s_memrealtime s[94:95]
    s_waitcnt lgkmcnt(0)
    s_or_b32 s94, s94, 1
    v_mov_b32 v6, s94
    v_mov_b32 v7, 0
    buffer_store_dword v6, v7, s[72:75], 0 offen sc1
k_notag:
    s_mov_b32 s8, s50
    s_and_b32 s9, s51, 0xffff
    s_mov_b32 s10, 20480000
    s_mov_b32 s11, 0x20000
    s_mov_b32 s12, s46
    s_and_b32 s13, s47, 0xffff
    s_mov_b32 s14, 8519680
    s_mov_b32 s15, 0x20000
    s_add_u32 s16, s46, 9437184
    s_addc_u32 s17, s47, 0
    s_and_b32 s17, s17, 0xffff
    s_mov_b32 s18, 53248
    s_mov_b32 s19, 0x20000
    s_add_u32 s76, s46, 9502720
    s_addc_u32 s77, s47, 0
    s_and_b32 s77, s77, 0xffff
    s_mov_b32 s78, 8192
    s_mov_b32 s79, 0x20000
    s_mov_b32 s20, s64
    s_and_b32 s21, s65, 0xffff
    s_mov_b32 s22, 1280000
    s_mov_b32 s23, 0x20000
    s_waitcnt vmcnt(0)
    s_mov_b32 s90, 109951163
    s_movk_i32 s91, 625
    s_movk_i32 s92, 144
    s_mov_b32 s93, 102400
    s_mov_b32 s94, 103428
    v_mov_b32 v5, 1
    v_lshlrev_b32 v7, 16, v0
    v_add_u32 v9, 2048, v0
    v_lshlrev_b32 v9, 14, v9
    v_mul_hi_u32 v32, v16, s90
    v_mul_hi_u32 v33, v17, s90
    v_mul_hi_u32 v34, v18, s90
    v_mul_hi_u32 v35, v19, s90
    v_lshl_add_u32 v36, v32, 2, s93
    ds_add_rtn_u32 v36, v36, v5
    v_lshl_add_u32 v37, v33, 2, s93
    ds_add_rtn_u32 v37, v37, v5
    v_lshl_add_u32 v38, v34, 2, s93
    ds_add_rtn_u32 v38, v38, v5
    v_lshl_add_u32 v39, v35, 2, s93
    ds_add_rtn_u32 v39, v39, v5
    v_mad_u32_u24 v40, v32, s91, 15
    v_lshrrev_b32 v40, 4, v40
    v_sub_u32 v40, v16, v40
    v_lshlrev_b32 v40, 26, v40
    v_mul_u32_u24 v44, s92, v32
    v_or3_b32 v40, v40, v7, v20
    v_add_u32 v44, s94, v44
    v_mad_u32_u24 v41, v33, s91, 15
    v_lshrrev_b32 v41, 4, v41
    v_sub_u32 v41, v17, v41
    v_lshlrev_b32 v41, 26, v41
    v_mul_u32_u24 v45, s92, v33
    v_or3_b32 v41, v41, v7, v21
    v_or_b32 v41, 16384, v41
    v_add_u32 v45, s94, v45
    v_mad_u32_u24 v42, v34, s91, 15
    v_lshrrev_b32 v42, 4, v42
    v_sub_u32 v42, v18, v42
    v_lshlrev_b32 v42, 26, v42
    v_mul_u32_u24 v46, s92, v34
    v_or3_b32 v42, v42, v7, v22
    v_or_b32 v42, 32768, v42
    v_add_u32 v46, s94, v46
    v_mad_u32_u24 v43, v35, s91, 15
    v_lshrrev_b32 v43, 4, v43
    v_sub_u32 v43, v19, v43
    v_lshlrev_b32 v43, 26, v43
    v_mul_u32_u24 v47, s92, v35
    v_or3_b32 v43, v43, v7, v23
    v_or_b32 v43, 49152, v43
    v_add_u32 v47, s94, v47
    v_cmp_gt_u32 vcc, 452, v0
    s_and_saveexec_b64 s[96:97], vcc
    v_mul_hi_u32 v48, v24, s90
    v_lshl_add_u32 v52, v48, 2, s93
    ds_add_rtn_u32 v52, v52, v5
    v_mad_u32_u24 v56, v48, s91, 15
    v_lshrrev_b32 v56, 4, v56
    v_sub_u32 v56, v24, v56
    v_lshlrev_b32 v56, 26, v56
    v_mul_u32_u24 v60, s92, v48
    v_or3_b32 v56, v56, v9, v28
    v_add_u32 v60, s94, v60
    s_waitcnt lgkmcnt(0)
    v_min_u32 v52, 31, v52
    v_lshl_add_u32 v52, v52, 2, v60
    ds_write_b32 v52, v56
    s_mov_b64 exec, s[96:97]
    v_min_u32 v36, 31, v36
    v_lshl_add_u32 v36, v36, 2, v44
    ds_write_b32 v36, v40
    v_min_u32 v37, 31, v37
    v_lshl_add_u32 v37, v37, 2, v45
    ds_write_b32 v37, v41
    v_min_u32 v38, 31, v38
    v_lshl_add_u32 v38, v38, 2, v46
    ds_write_b32 v38, v42
    v_min_u32 v39, 31, v39
    v_lshl_add_u32 v39, v39, 2, v47
    ds_write_b32 v39, v43
    v_lshrrev_b32 v4, 2, v0
    v_and_b32 v5, 3, v0
    v_mul_u32_u24 v6, 144, v4
    v_lshl_add_u32 v6, v5, 4, v6
    v_add_u32 v6, 103424, v6
    v_lshlrev_b32 v7, 2, v4
    v_add_u32 v7, 102400, v7
    v_lshlrev_b32 v8, 4, v0
    s_mul_i32 s90, s2, 16640
    s_add_u32 s91, s90, 8192
    s_add_u32 s92, s90, 4259840
    s_add_u32 s93, s92, 8192
    s_waitcnt lgkmcnt(0)
    s_barrier
    ds_read_b32 v32, v7 offset:0
    ds_read_b128 v[16:19], v6 offset:0
    ds_read_b128 v[24:27], v6 offset:64
    ds_read_b32 v33, v7 offset:512
    ds_read_b128 v[20:23], v6 offset:18432
    ds_read_b128 v[28:31], v6 offset:18496
    v_mov_b32 v9, 0
    buffer_load_dword v73, v9, s[72:75], 0 offen sc1
    v_cmp_eq_u32 vcc, 0, v5
    s_nop 0
    s_waitcnt lgkmcnt(0)
    v_cndmask_b32 v16, v16, v32, vcc
    v_cndmask_b32 v20, v20, v33, vcc
    buffer_store_dwordx4 v[16:19], v8, s[12:15], s90 offen sc1
    buffer_store_dwordx4 v[20:23], v8, s[12:15], s91 offen sc1
    v_cmp_lt_u32 vcc, 15, v32
    s_and_saveexec_b64 s[96:97], vcc
    s_cbranch_execz pa_nob_0
    buffer_store_dwordx4 v[24:27], v8, s[12:15], s92 offen sc1
pa_nob_0:
    s_mov_b64 exec, s[96:97]
    v_cmp_lt_u32 vcc, 15, v33
    s_and_saveexec_b64 s[96:97], vcc
    s_cbranch_execz pa_nob_1
    buffer_store_dwordx4 v[28:31], v8, s[12:15], s93 offen sc1
pa_nob_1:
    s_mov_b64 exec, s[96:97]
    s_cmp_eq_u32 s42, 7
    s_cbranch_scc0 pa_now2
    s_cmp_lt_u32 s2, 144
    s_cbranch_scc0 pa_now2
    v_lshl_or_b32 v86, v84, 16, v83
    s_cmp_eq_u32 s89, 0
    s_cbranch_scc1 pa_w_st
    v_lshlrev_b32 v83, 16, v83
    v_lshlrev_b32 v84, 16, v84
    s_mov_b32 s98, 0xbfb8aa3b
    v_mul_f32 v83, s98, v83
    v_mul_f32 v84, s98, v84
    v_cvt_pk_bf16_f32 v86, v83, v84
pa_w_st:
    buffer_store_dword v86, v85, s[16:19], 0 offen sc1
pa_now2:
    s_waitcnt vmcnt(0)
    s_barrier
    s_cmp_eq_u32 s42, 0
    s_cbranch_scc0 k_nosig
    v_readfirstlane_b32 s81, v73
    s_mov_b32 s91, 400000
k_tagpoll:
    s_cmp_lg_u32 s81, 0
    s_cbranch_scc1 k_tagdone
    v_mov_b32 v6, 0
    buffer_load_dword v7, v6, s[72:75], 0 offen sc1
    s_waitcnt vmcnt(0)
    v_readfirstlane_b32 s81, v7
    s_sub_u32 s91, s91, 1
    s_cbranch_scc0 k_tagpoll
k_tagdone:
    s_lshr_b32 s92, s2, 2
    s_lshl_b32 s92, s92, 7
    s_and_b32 s93, s2, 3
    s_lshl_b32 s93, s93, 2
    s_add_u32 s92, s92, s93
    v_mov_b32 v6, s92
    v_mov_b32 v7, s81
    s_mov_b64 s[96:97], exec
    s_mov_b64 exec, 1
    buffer_store_dword v7, v6, s[76:79], 0 offen sc1
    s_mov_b64 exec, s[96:97]
k_nosig:
    s_cmp_eq_u32 s42, 0
    s_cbranch_scc1 k_w0c
    v_and_b32 v10, 31, v1
    v_lshrrev_b32 v11, 5, v1
    s_lshr_b32 s94, s42, 2
    s_and_b32 s95, s42, 3
    s_lshl_b32 s96, s94, 5
    s_add_u32 s96, s96, s43
    v_add_u32 v12, s96, v10
    v_lshlrev_b32 v12, 7, v12
    v_lshl_add_u32 v12, v11, 4, v12
    buffer_load_dwordx4 v[96:99], v12, s[4:7], s83 offen offset:0
    buffer_load_dwordx4 v[100:103], v12, s[4:7], s83 offen offset:32
    buffer_load_dwordx4 v[104:107], v12, s[4:7], s83 offen offset:64
    buffer_load_dwordx4 v[108:111], v12, s[4:7], s83 offen offset:96
    s_lshl_b32 s97, s95, 6
    v_lshl_add_u32 v12, v10, 1, s97
    buffer_load_ushort v168, v12, s[24:27], 0 offen
    s_cmp_ge_u32 s42, 4
    s_cbranch_scc0 k_now1b
    v_and_b32 v12, 255, v0
    v_lshlrev_b32 v12, 4, v12
    s_movk_i32 s94, 16384
    buffer_load_dwordx4 v[48:51], v12, s[28:31], s94 offen
    s_movk_i32 s94, 20480
    buffer_load_dwordx4 v[52:55], v12, s[28:31], s94 offen
    s_movk_i32 s94, 24576
    buffer_load_dwordx4 v[56:59], v12, s[28:31], s94 offen
    s_movk_i32 s94, 28672
    buffer_load_dwordx4 v[60:63], v12, s[28:31], s94 offen
k_now1b:
    s_lshr_b32 s90, s2, 3
    s_mul_i32 s90, s90, 40000
    s_sub_u32 s91, s42, 1
    s_mul_i32 s91, s91, 6144
    s_add_u32 s90, s90, s91
    s_add_u32 s90, s90, 3120
    s_add_u32 s91, s90, 4096
    v_lshlrev_b32 v6, 4, v1
    buffer_load_dwordx4 v[16:19], v6, s[4:7], s90 offen offset:0
    buffer_load_dwordx4 v[16:19], v6, s[4:7], s90 offen offset:1024
    buffer_load_dwordx4 v[16:19], v6, s[4:7], s90 offen offset:2048
    buffer_load_dwordx4 v[16:19], v6, s[4:7], s90 offen offset:3072
    buffer_load_dwordx4 v[16:19], v6, s[4:7], s91 offen offset:0
    buffer_load_dwordx4 v[16:19], v6, s[4:7], s91 offen offset:1024
k_w0c:
    v_lshrrev_b32 v2, 3, v1
    v_and_b32 v3, 7, v1
    v_and_b32 v4, 31, v1
    v_lshrrev_b32 v5, 5, v1
    s_mul_i32 s86, s42, 4160
    s_add_u32 s86, s86, 52032
    s_lshl_b32 s87, s42, 11
    s_add_u32 s87, s87, 86016
    s_mov_b32 s40, 0x33800000
    s_mov_b32 s41, 0x33800000
    s_mov_b32 s47, 0
    s_mov_b32 s80, 0
    v_lshlrev_b32 v7, 1, v2
    v_and_b32 v7, 4, v7
    v_xor_b32 v7, v3, v7
    v_lshlrev_b32 v232, 4, v7
    v_lshrrev_b32 v7, 4, v1
    v_xor_b32 v7, v1, v7
    v_and_b32 v7, 1, v7
    v_lshlrev_b32 v233, 4, v7
    v_and_b32 v7, 3, v4
    v_bfe_u32 v8, v4, 2, 1
    v_lshrrev_b32 v9, 3, v4
    v_lshl_add_u32 v10, v8, 2, v9
    v_mul_u32_u24 v11, 1040, v7
    v_lshl_add_u32 v11, v10, 7, v11
    v_lshl_add_u32 v11, v5, 4, v11
    v_add_u32 v11, s86, v11
    v_bfe_u32 v12, v10, 1, 1
    v_lshlrev_b32 v12, 6, v12
    v_add_u32 v234, v11, v12
    v_sub_u32 v235, v11, v12
    v_lshl_add_u32 v11, v10, 2, v7
    v_bfe_u32 v12, v11, 3, 1
    v_xor_b32 v12, v5, v12
    v_lshlrev_b32 v12, 4, v12
    v_lshl_add_u32 v12, v11, 5, v12
    v_add_u32 v236, s87, v12
    v_lshlrev_b32 v237, 2, v4
    v_add_u32 v237, 31040, v237
    v_lshlrev_b32 v12, 2, v5
    v_sub_u32 v12, v10, v12
    v_mov_b32 v15, 0x3f803f80
    v_cmp_eq_u32 s[90:91], 0, v12
    v_cmp_eq_u32 s[92:93], 1, v12
    v_cmp_eq_u32 s[94:95], 2, v12
    v_cmp_eq_u32 s[96:97], 3, v12
    v_cmp_eq_u32 vcc, v8, v5
    v_cndmask_b32_e64 v200, 0, v15, s[90:91]
    v_cndmask_b32_e64 v201, 0, v15, s[92:93]
    v_cndmask_b32_e64 v202, 0, v15, s[94:95]
    v_cndmask_b32_e64 v203, 0, v15, s[96:97]
    v_mov_b32 v188, 0
    v_mov_b32 v189, 0
    v_mov_b32 v190, 0
    v_mov_b32 v191, 0
    v_mov_b32 v192, 0
    v_mov_b32 v193, 0
    v_mov_b32 v194, 0
    v_mov_b32 v195, 0
    v_mov_b32 v196, 0
    v_mov_b32 v197, 0
    v_mov_b32 v198, 0
    v_mov_b32 v199, 0
    v_cndmask_b32 v196, 0, v15, vcc
    v_mov_b32 v244, 0
    v_mov_b32 v245, 0
    v_mov_b32 v246, 0
    v_mov_b32 v247, 0
    v_mov_b32 v248, 0
    v_mov_b32 v249, 0
    v_mov_b32 v250, 0
    v_mov_b32 v251, 0
    v_mov_b32 v252, 0
    v_mov_b32 v253, 0
    v_lshlrev_b32 v241, 4, v0
    v_mov_b32 v212, 0x7fffff00
    v_mov_b32 v213, 0x7fffff00
    v_mov_b32 v214, 0x7fffff00
    v_mov_b32 v215, 0x7fffff00
    ds_write_b128 v241, v[212:215] offset:1088
    ds_write_b128 v241, v[212:215] offset:9280
    ds_write_b128 v241, v[212:215] offset:17472
    v_cmp_gt_u32 vcc, 128, v0
    s_and_saveexec_b64 s[98:99], vcc
    ds_write_b128 v241, v[212:215] offset:25664
    s_mov_b64 exec, s[98:99]
    v_mov_b32 v216, 20480
    v_mov_b32 v217, 20480
    v_mov_b32 v218, 20480
    v_mov_b32 v219, 20480
    v_cmp_gt_u32 vcc, 208, v0
    s_and_saveexec_b64 s[98:99], vcc
    ds_write_b128 v241, v[216:219] offset:27712
    s_mov_b64 exec, s[98:99]
    v_mov_b32 v212, 0
    v_mov_b32 v213, 0
    v_mov_b32 v214, 0
    v_mov_b32 v215, 0
    v_cmp_gt_u32 vcc, 32, v0
    s_and_saveexec_b64 s[98:99], vcc
    ds_write_b128 v241, v[212:215] offset:51520
    s_mov_b64 exec, s[98:99]
    v_lshlrev_b32 v243, 4, v0
    v_add_u32 v243, 160768, v243
    v_cmp_gt_u32 vcc, 64, v0
    s_and_saveexec_b64 s[98:99], vcc
    ds_write_b128 v243, v[212:215] offset:0
    s_mov_b64 exec, s[98:99]
    v_lshrrev_b32 v2, 2, v1
    s_lshl_b32 s90, s42, 5
    v_add_u32 v2, s90, v2
    v_mul_u32_u24 v2, 2500, v2
    v_mov_b32 v208, v2
    v_add_u32 v209, 40000, v2
    v_and_b32 v3, 3, v1
    v_lshlrev_b32 v220, 2, v3
    v_add_u32 v220, -1, v220
    v_lshlrev_b32 v221, 2, v3
    v_add_u32 v221, 0, v221
    v_lshlrev_b32 v222, 2, v3
    v_add_u32 v222, 1, v222
    v_lshlrev_b32 v223, 2, v3
    v_add_u32 v223, 2, v223
    s_cmp_ge_u32 s42, 4
    s_cbranch_scc0 k_nostage
    s_waitcnt vmcnt(6)
    v_and_b32 v9, 255, v0
    v_lshlrev_b32 v9, 4, v9
    v_add_u32 v9, 52032, v9
    ds_write_b128 v9, v[48:51] offset:0
    ds_write_b128 v9, v[52:55] offset:4096
    ds_write_b128 v9, v[56:59] offset:8192
    ds_write_b128 v9, v[60:63] offset:12288
    s_waitcnt lgkmcnt(0)
k_nostage:
    s_cmp_eq_u32 s42, 0
    s_cbranch_scc0 k_wait_done
k_dopoll:
    v_lshlrev_b32 v6, 7, v1
    s_mov_b32 s91, 400000
    s_sleep 12
k_poll:
    buffer_load_dwordx4 v[8:11], v6, s[76:79], 0 offen sc0 sc1
    s_waitcnt vmcnt(0)
    v_cmp_ne_u32 vcc, s81, v8
    v_cmp_ne_u32 s[94:95], s81, v9
    s_or_b64 vcc, vcc, s[94:95]
    v_cmp_ne_u32 s[94:95], s81, v10
    s_or_b64 vcc, vcc, s[94:95]
    v_cmp_ne_u32 s[94:95], s81, v11
    s_or_b64 vcc, vcc, s[94:95]
    s_cmp_eq_u64 vcc, 0
    s_cbranch_scc1 k_wait_done
    s_sub_u32 s91, s91, 1
    s_cbranch_scc1 k_wait_done
    s_sleep 4
    s_branch k_poll
k_wait_done:
    s_mov_b32 s28, s62
    s_and_b32 s29, s63, 0xffff
    s_mov_b32 s30, 128
    s_mov_b32 s31, 0x20000
    v_lshrrev_b32 v15, 2, v1
    v_mul_u32_u24 v15, 16640, v15
    v_and_b32 v14, 3, v1
    v_lshl_add_u32 v13, v14, 4, v15
    s_mul_i32 s90, s42, 532480
    s_lshl_b32 s91, s2, 6
    s_add_u32 s90, s90, s91
    s_add_u32 s91, s90, 266240
    s_add_u32 s92, s90, 4259840
    s_add_u32 s93, s91, 4259840
    v_lshlrev_b32 v14, 4, v1
    s_lshl_b32 s96, s42, 10
    s_add_u32 s95, s96, 8192
    s_add_u32 s97, s96, 16384
    s_cmp_eq_u32 s42, 0
    s_cbranch_scc0 k_w0r
    s_mov_b32 s82, s95
    s_mov_b32 s88, s96
    s_mov_b32 s89, s97
    v_and_b32 v10, 31, v1
    v_lshrrev_b32 v11, 5, v1
    s_lshr_b32 s94, s42, 2
    s_and_b32 s95, s42, 3
    s_lshl_b32 s96, s94, 5
    s_add_u32 s96, s96, s43
    v_add_u32 v12, s96, v10
    v_lshlrev_b32 v12, 7, v12
    v_lshl_add_u32 v12, v11, 4, v12
    buffer_load_dwordx4 v[96:99], v12, s[4:7], s83 offen offset:0
    buffer_load_dwordx4 v[100:103], v12, s[4:7], s83 offen offset:32
    buffer_load_dwordx4 v[104:107], v12, s[4:7], s83 offen offset:64
    buffer_load_dwordx4 v[108:111], v12, s[4:7], s83 offen offset:96
    s_lshl_b32 s97, s95, 6
    v_lshl_add_u32 v12, v10, 1, s97
    buffer_load_ushort v168, v12, s[24:27], 0 offen
    s_mov_b32 s95, s82
    s_mov_b32 s96, s88
    s_mov_b32 s97, s89
k_w0r:
    s_waitcnt lgkmcnt(0)
    s_barrier
    buffer_load_dwordx4 v[116:119], v13, s[12:15], s90 offen sc1
    buffer_load_dwordx4 v[120:123], v13, s[12:15], s91 offen sc1
    s_waitcnt vmcnt(2)
    v_bfe_u32 v11, v1, 2, 2
    v_lshrrev_b32 v12, 5, v1
    v_lshl_add_u32 v11, v12, 3, v11
    v_lshlrev_b32 v11, 8, v11
    v_bfe_u32 v12, v1, 4, 1
    v_lshl_add_u32 v11, v12, 5, v11
    v_and_b32 v12, 3, v1
    v_lshl_add_u32 v11, v12, 3, v11
    s_and_b32 s92, s42, 3
    s_lshl_b32 s92, s92, 6
    s_add_u32 s92, s92, 52032
    v_add_u32 v11, s92, v11
    ds_read_b64_tr_b16 v[172:173], v11 offset:0
    ds_read_b64_tr_b16 v[174:175], v11 offset:1024
    ds_read_b64_tr_b16 v[176:177], v11 offset:4096
    ds_read_b64_tr_b16 v[178:179], v11 offset:5120
    ds_read_b64_tr_b16 v[180:181], v11 offset:8192
    ds_read_b64_tr_b16 v[182:183], v11 offset:9216
    ds_read_b64_tr_b16 v[184:185], v11 offset:12288
    ds_read_b64_tr_b16 v[186:187], v11 offset:13312
    s_waitcnt lgkmcnt(0)
    v_mfma_f32_32x32x16_bf16 v[32:47], v[96:99], v[172:175], 0
    v_mfma_f32_32x32x16_bf16 v[32:47], v[100:103], v[176:179], v[32:47]
    v_mfma_f32_32x32x16_bf16 v[32:47], v[104:107], v[180:183], v[32:47]
    v_mfma_f32_32x32x16_bf16 v[32:47], v[108:111], v[184:187], v[32:47]
    v_lshlrev_b32 v168, 16, v168
    s_mov_b32 s95, 0xbfb8aa3b
    s_lshr_b32 s91, s42, 2
    s_and_b32 s92, s42, 3
    v_lshrrev_b32 v5, 5, v1
    v_and_b32 v4, 31, v1
    s_lshl_b32 s93, s91, 14
    s_lshl_b32 s94, s92, 7
    s_add_u32 s93, s93, s94
    s_add_u32 s93, s93, 31040
    v_lshlrev_b32 v12, 11, v5
    v_lshl_add_u32 v12, v4, 2, v12
    v_add_u32 v12, s93, v12
    s_nop 1
    v_add_f32 v32, v32, v168
    v_mul_f32 v32, s95, v32
    v_cvt_pk_bf16_f32 v212, v32, v32
    v_lshlrev_b32 v242, 16, v212
    v_sub_f32 v242, v32, v242
    v_cvt_pk_bf16_f32 v212, v32, v242
    ds_write_b32 v12, v212 offset:0
    v_add_f32 v33, v33, v168
    v_mul_f32 v33, s95, v33
    v_cvt_pk_bf16_f32 v213, v33, v33
    v_lshlrev_b32 v242, 16, v213
    v_sub_f32 v242, v33, v242
    v_cvt_pk_bf16_f32 v213, v33, v242
    ds_write_b32 v12, v213 offset:512
    v_add_f32 v34, v34, v168
    v_mul_f32 v34, s95, v34
    v_cvt_pk_bf16_f32 v214, v34, v34
    v_lshlrev_b32 v242, 16, v214
    v_sub_f32 v242, v34, v242
    v_cvt_pk_bf16_f32 v214, v34, v242
    ds_write_b32 v12, v214 offset:1024
    v_add_f32 v35, v35, v168
    v_mul_f32 v35, s95, v35
    v_cvt_pk_bf16_f32 v215, v35, v35
    v_lshlrev_b32 v242, 16, v215
    v_sub_f32 v242, v35, v242
    v_cvt_pk_bf16_f32 v215, v35, v242
    ds_write_b32 v12, v215 offset:1536
    s_cmp_eq_u32 s91, 0
    s_cbranch_scc0 k_qdone
    v_add_f32 v36, v36, v168
    v_mul_f32 v36, s95, v36
    v_cvt_pk_bf16_f32 v212, v36, v36
    v_lshlrev_b32 v242, 16, v212
    v_sub_f32 v242, v36, v242
    v_cvt_pk_bf16_f32 v212, v36, v242
    ds_write_b32 v12, v212 offset:4096
    v_add_f32 v37, v37, v168
    v_mul_f32 v37, s95, v37
    v_cvt_pk_bf16_f32 v213, v37, v37
    v_lshlrev_b32 v242, 16, v213
    v_sub_f32 v242, v37, v242
    v_cvt_pk_bf16_f32 v213, v37, v242
    ds_write_b32 v12, v213 offset:4608
    v_add_f32 v38, v38, v168
    v_mul_f32 v38, s95, v38
    v_cvt_pk_bf16_f32 v214, v38, v38
    v_lshlrev_b32 v242, 16, v214
    v_sub_f32 v242, v38, v242
    v_cvt_pk_bf16_f32 v214, v38, v242
    ds_write_b32 v12, v214 offset:5120
    v_add_f32 v39, v39, v168
    v_mul_f32 v39, s95, v39
    v_cvt_pk_bf16_f32 v215, v39, v39
    v_lshlrev_b32 v242, 16, v215
    v_sub_f32 v242, v39, v242
    v_cvt_pk_bf16_f32 v215, v39, v242
    ds_write_b32 v12, v215 offset:5632
    v_add_f32 v40, v40, v168
    v_mul_f32 v40, s95, v40
    v_cvt_pk_bf16_f32 v212, v40, v40
    v_lshlrev_b32 v242, 16, v212
    v_sub_f32 v242, v40, v242
    v_cvt_pk_bf16_f32 v212, v40, v242
    ds_write_b32 v12, v212 offset:8192
    v_add_f32 v41, v41, v168
    v_mul_f32 v41, s95, v41
    v_cvt_pk_bf16_f32 v213, v41, v41
    v_lshlrev_b32 v242, 16, v213
    v_sub_f32 v242, v41, v242
    v_cvt_pk_bf16_f32 v213, v41, v242
    ds_write_b32 v12, v213 offset:8704
    v_add_f32 v42, v42, v168
    v_mul_f32 v42, s95, v42
    v_cvt_pk_bf16_f32 v214, v42, v42
    v_lshlrev_b32 v242, 16, v214
    v_sub_f32 v242, v42, v242
    v_cvt_pk_bf16_f32 v214, v42, v242
    ds_write_b32 v12, v214 offset:9216
    v_add_f32 v43, v43, v168
    v_mul_f32 v43, s95, v43
    v_cvt_pk_bf16_f32 v215, v43, v43
    v_lshlrev_b32 v242, 16, v215
    v_sub_f32 v242, v43, v242
    v_cvt_pk_bf16_f32 v215, v43, v242
    ds_write_b32 v12, v215 offset:9728
    v_add_f32 v44, v44, v168
    v_mul_f32 v44, s95, v44
    v_cvt_pk_bf16_f32 v212, v44, v44
    v_lshlrev_b32 v242, 16, v212
    v_sub_f32 v242, v44, v242
    v_cvt_pk_bf16_f32 v212, v44, v242
    ds_write_b32 v12, v212 offset:12288
    v_add_f32 v45, v45, v168
    v_mul_f32 v45, s95, v45
    v_cvt_pk_bf16_f32 v213, v45, v45
    v_lshlrev_b32 v242, 16, v213
    v_sub_f32 v242, v45, v242
    v_cvt_pk_bf16_f32 v213, v45, v242
    ds_write_b32 v12, v213 offset:12800
    v_add_f32 v46, v46, v168
    v_mul_f32 v46, s95, v46
    v_cvt_pk_bf16_f32 v214, v46, v46
    v_lshlrev_b32 v242, 16, v214
    v_sub_f32 v242, v46, v242
    v_cvt_pk_bf16_f32 v214, v46, v242
    ds_write_b32 v12, v214 offset:13312
    v_add_f32 v47, v47, v168
    v_mul_f32 v47, s95, v47
    v_cvt_pk_bf16_f32 v215, v47, v47
    v_lshlrev_b32 v242, 16, v215
    v_sub_f32 v242, v47, v242
    v_cvt_pk_bf16_f32 v215, v47, v242
    ds_write_b32 v12, v215 offset:13824
k_qdone:
    s_add_u32 s92, s90, 4259840
    s_add_u32 s93, s92, 266240
    v_add_u32 v212, 16, v220
    v_add_u32 v213, 16, v221
    v_add_u32 v214, 16, v222
    v_add_u32 v215, 16, v223
    s_waitcnt vmcnt(0)
    v_mov_b32_dpp v164, v116 quad_perm:[0,0,0,0] row_mask:0xf bank_mask:0xf
    v_mov_b32_dpp v165, v120 quad_perm:[0,0,0,0] row_mask:0xf bank_mask:0xf
    s_nop 1
    v_cmp_lt_u32 vcc, 15, v164
    s_and_saveexec_b64 s[98:99], vcc
    s_cbranch_execz k_nob_0
    buffer_load_dwordx4 v[124:127], v13, s[12:15], s92 offen sc1
k_nob_0:
    s_mov_b64 exec, s[98:99]
    v_cmp_lt_u32 vcc, 15, v165
    s_and_saveexec_b64 s[98:99], vcc
    s_cbranch_execz k_nob_1
    buffer_load_dwordx4 v[128:131], v13, s[12:15], s93 offen sc1
k_nob_1:
    s_mov_b64 exec, s[98:99]
    s_lshl_b32 s96, s42, 10
    s_add_u32 s95, s96, 8192
    s_add_u32 s97, s96, 16384
    buffer_load_dwordx4 v[16:19], v14, s[16:19], s96 offen sc1
    buffer_load_dwordx4 v[20:23], v14, s[16:19], s95 offen sc1
    buffer_load_dwordx4 v[24:27], v14, s[16:19], s97 offen sc1
    v_cmp_lt_u32 s[48:49], v220, v164
    v_cmp_lt_u32 s[50:51], v221, v164
    v_cmp_lt_u32 s[52:53], v222, v164
    v_cmp_lt_u32 s[54:55], v223, v164
    v_cmp_lt_u32 s[56:57], v220, v165
    v_cmp_lt_u32 s[58:59], v221, v165
    v_cmp_lt_u32 s[60:61], v222, v165
    v_cmp_lt_u32 s[62:63], v223, v165
    v_cmp_lt_u32 s[64:65], v212, v164
    v_cmp_lt_u32 s[66:67], v213, v164
    v_cmp_lt_u32 s[68:69], v214, v164
    v_cmp_lt_u32 s[70:71], v215, v164
    v_cmp_lt_u32 s[72:73], v212, v165
    v_cmp_lt_u32 s[74:75], v213, v165
    v_cmp_lt_u32 s[76:77], v214, v165
    v_cmp_lt_u32 s[78:79], v215, v165
    v_max_u32 v241, v164, v165
    v_cmp_lt_u32 vcc, 31, v241
    s_cbranch_vccz k_noovf
    v_mov_b32 v241, 768
    v_mov_b32 v242, 1
    ds_write_b32 v241, v242
k_noovf:
    v_mov_b32 v242, 1
    v_lshrrev_b32 v132, 26, v116
    v_lshlrev_b32 v148, 2, v132
    v_lshrrev_b32 v133, 26, v117
    v_lshlrev_b32 v149, 2, v133
    v_lshrrev_b32 v134, 26, v118
    v_lshlrev_b32 v150, 2, v134
    v_lshrrev_b32 v135, 26, v119
    v_lshlrev_b32 v151, 2, v135
    v_lshrrev_b32 v136, 26, v120
    v_lshlrev_b32 v152, 2, v136
    v_lshrrev_b32 v137, 26, v121
    v_lshlrev_b32 v153, 2, v137
    v_lshrrev_b32 v138, 26, v122
    v_lshlrev_b32 v154, 2, v138
    v_lshrrev_b32 v139, 26, v123
    v_lshlrev_b32 v155, 2, v139
    s_mov_b64 exec, s[48:49]
    ds_add_rtn_u32 v148, v148, v242
    s_mov_b64 exec, s[50:51]
    ds_add_rtn_u32 v149, v149, v242
    s_mov_b64 exec, s[52:53]
    ds_add_rtn_u32 v150, v150, v242
    s_mov_b64 exec, s[54:55]
    ds_add_rtn_u32 v151, v151, v242
    s_mov_b64 exec, s[56:57]
    ds_add_rtn_u32 v152, v152, v242
    s_mov_b64 exec, s[58:59]
    ds_add_rtn_u32 v153, v153, v242
    s_mov_b64 exec, s[60:61]
    ds_add_rtn_u32 v154, v154, v242
    s_mov_b64 exec, s[62:63]
    ds_add_rtn_u32 v155, v155, v242
    s_waitcnt vmcnt(3)
    s_mov_b64 exec, s[64:65]
    s_cbranch_execz k_hskip_1_8
    v_lshrrev_b32 v140, 26, v124
    v_lshlrev_b32 v156, 2, v140
    ds_add_rtn_u32 v156, v156, v242
k_hskip_1_8:
    s_mov_b64 exec, s[66:67]
    s_cbranch_execz k_hskip_1_9
    v_lshrrev_b32 v141, 26, v125
    v_lshlrev_b32 v157, 2, v141
    ds_add_rtn_u32 v157, v157, v242
k_hskip_1_9:
    s_mov_b64 exec, s[68:69]
    s_cbranch_execz k_hskip_1_10
    v_lshrrev_b32 v142, 26, v126
    v_lshlrev_b32 v158, 2, v142
    ds_add_rtn_u32 v158, v158, v242
k_hskip_1_10:
    s_mov_b64 exec, s[70:71]
    s_cbranch_execz k_hskip_1_11
    v_lshrrev_b32 v143, 26, v127
    v_lshlrev_b32 v159, 2, v143
    ds_add_rtn_u32 v159, v159, v242
k_hskip_1_11:
    s_mov_b64 exec, s[72:73]
    s_cbranch_execz k_hskip_1_12
    v_lshrrev_b32 v144, 26, v128
    v_lshlrev_b32 v160, 2, v144
    ds_add_rtn_u32 v160, v160, v242
k_hskip_1_12:
    s_mov_b64 exec, s[74:75]
    s_cbranch_execz k_hskip_1_13
    v_lshrrev_b32 v145, 26, v129
    v_lshlrev_b32 v161, 2, v145
    ds_add_rtn_u32 v161, v161, v242
k_hskip_1_13:
    s_mov_b64 exec, s[76:77]
    s_cbranch_execz k_hskip_1_14
    v_lshrrev_b32 v146, 26, v130
    v_lshlrev_b32 v162, 2, v146
    ds_add_rtn_u32 v162, v162, v242
k_hskip_1_14:
    s_mov_b64 exec, s[78:79]
    s_cbranch_execz k_hskip_1_15
    v_lshrrev_b32 v147, 26, v131
    v_lshlrev_b32 v163, 2, v147
    ds_add_rtn_u32 v163, v163, v242
k_hskip_1_15:
    s_mov_b64 exec, -1
    s_waitcnt lgkmcnt(0)
    s_barrier
k_scan:
    v_lshlrev_b32 v241, 2, v1
    ds_read_b32 v172, v241 offset:0
    v_mov_b32 v242, 768
    ds_read_b32 v173, v242
    s_waitcnt lgkmcnt(0)
    v_add_u32 v174, 3, v172
    v_and_b32 v174, -4, v174
    v_mov_b32 v175, v174
    s_nop 1
    v_add_u32_dpp v175, v175, v175 row_shr:1 row_mask:0xf bank_mask:0xf
    s_nop 1
    v_add_u32_dpp v175, v175, v175 row_shr:2 row_mask:0xf bank_mask:0xf
    s_nop 1
    v_add_u32_dpp v175, v175, v175 row_shr:4 row_mask:0xf bank_mask:0xf
    s_nop 1
    v_add_u32_dpp v175, v175, v175 row_shr:8 row_mask:0xf bank_mask:0xf
    s_nop 1
    v_add_u32_dpp v175, v175, v175 row_bcast:15 row_mask:0xa bank_mask:0xf
    s_nop 1
    v_add_u32_dpp v175, v175, v175 row_bcast:31 row_mask:0xc bank_mask:0xf
    s_nop 0
    v_readlane_b32 s46, v175, 63
    v_readfirstlane_b32 s90, v173
    v_sub_u32 v175, v175, v174
    s_bitcmp1_b32 s47, 0
    s_cbranch_scc1 k_okcap
    s_cmp_gt_u32 s46, 3328
    s_cselect_b32 s91, 1, 0
    s_or_b32 s90, s90, s91
    s_cmp_lg_u32 s90, 0
    s_cbranch_scc1 k_goslow
k_okcap:
    s_add_u32 s45, s46, 31
    s_lshr_b32 s45, s45, 5
    v_lshlrev_b32 v242, 2, v132
    ds_bpermute_b32 v96, v242, v175
    v_lshlrev_b32 v242, 2, v133
    ds_bpermute_b32 v97, v242, v175
    v_lshlrev_b32 v242, 2, v134
    ds_bpermute_b32 v98, v242, v175
    v_lshlrev_b32 v242, 2, v135
    ds_bpermute_b32 v99, v242, v175
    v_lshlrev_b32 v242, 2, v136
    ds_bpermute_b32 v100, v242, v175
    v_lshlrev_b32 v242, 2, v137
    ds_bpermute_b32 v101, v242, v175
    v_lshlrev_b32 v242, 2, v138
    ds_bpermute_b32 v102, v242, v175
    v_lshlrev_b32 v242, 2, v139
    ds_bpermute_b32 v103, v242, v175
    s_cmp_eq_u64 s[64:65], 0
    s_cbranch_scc1 k_bskip_8
    v_lshlrev_b32 v242, 2, v140
    ds_bpermute_b32 v104, v242, v175
k_bskip_8:
    s_cmp_eq_u64 s[66:67], 0
    s_cbranch_scc1 k_bskip_9
    v_lshlrev_b32 v242, 2, v141
    ds_bpermute_b32 v105, v242, v175
k_bskip_9:
    s_cmp_eq_u64 s[68:69], 0
    s_cbranch_scc1 k_bskip_10
    v_lshlrev_b32 v242, 2, v142
    ds_bpermute_b32 v106, v242, v175
k_bskip_10:
    s_cmp_eq_u64 s[70:71], 0
    s_cbranch_scc1 k_bskip_11
    v_lshlrev_b32 v242, 2, v143
    ds_bpermute_b32 v107, v242, v175
k_bskip_11:
    s_cmp_eq_u64 s[72:73], 0
    s_cbranch_scc1 k_bskip_12
    v_lshlrev_b32 v242, 2, v144
    ds_bpermute_b32 v108, v242, v175
k_bskip_12:
    s_cmp_eq_u64 s[74:75], 0
    s_cbranch_scc1 k_bskip_13
    v_lshlrev_b32 v242, 2, v145
    ds_bpermute_b32 v109, v242, v175
k_bskip_13:
    s_cmp_eq_u64 s[76:77], 0
    s_cbranch_scc1 k_bskip_14
    v_lshlrev_b32 v242, 2, v146
    ds_bpermute_b32 v110, v242, v175
k_bskip_14:
    s_cmp_eq_u64 s[78:79], 0
    s_cbranch_scc1 k_bskip_15
    v_lshlrev_b32 v242, 2, v147
    ds_bpermute_b32 v111, v242, v175
k_bskip_15:
    s_cmp_eq_u32 s42, 0
    s_cbranch_scc0 k_nodeg
    ds_add_u32 v241, v172 offset:256
    ds_write_b32 v241, v175 offset:832
k_nodeg:
    s_movk_i32 s90, 0x3fff
    v_lshlrev_b32 v132, 9, v132
    v_bfe_u32 v212, v116, 14, 12
    v_and_b32 v116, s90, v116
    v_add_lshl_u32 v212, v212, v208, 5
    v_lshlrev_b32 v116, 7, v116
    v_lshlrev_b32 v133, 9, v133
    v_bfe_u32 v213, v117, 14, 12
    v_and_b32 v117, s90, v117
    v_add_lshl_u32 v213, v213, v208, 5
    v_lshlrev_b32 v117, 7, v117
    v_lshlrev_b32 v134, 9, v134
    v_bfe_u32 v214, v118, 14, 12
    v_and_b32 v118, s90, v118
    v_add_lshl_u32 v214, v214, v208, 5
    v_lshlrev_b32 v118, 7, v118
    v_lshlrev_b32 v135, 9, v135
    v_bfe_u32 v215, v119, 14, 12
    v_and_b32 v119, s90, v119
    v_add_lshl_u32 v215, v215, v208, 5
    v_lshlrev_b32 v119, 7, v119
    v_lshlrev_b32 v136, 9, v136
    v_bfe_u32 v216, v120, 14, 12
    v_and_b32 v120, s90, v120
    v_add_lshl_u32 v216, v216, v209, 5
    v_lshlrev_b32 v120, 7, v120
    v_lshlrev_b32 v137, 9, v137
    v_bfe_u32 v217, v121, 14, 12
    v_and_b32 v121, s90, v121
    v_add_lshl_u32 v217, v217, v209, 5
    v_lshlrev_b32 v121, 7, v121
    v_lshlrev_b32 v138, 9, v138
    v_bfe_u32 v218, v122, 14, 12
    v_and_b32 v122, s90, v122
    v_add_lshl_u32 v218, v218, v209, 5
    v_lshlrev_b32 v122, 7, v122
    v_lshlrev_b32 v139, 9, v139
    v_bfe_u32 v219, v123, 14, 12
    v_and_b32 v123, s90, v123
    v_add_lshl_u32 v219, v219, v209, 5
    v_lshlrev_b32 v123, 7, v123
    s_waitcnt lgkmcnt(0)
    v_add_u32 v96, v96, v148
    v_and_b32 v242, -4, v96
    v_lshlrev_b32 v96, 2, v96
    s_mov_b64 exec, s[48:49]
    ds_write_b32 v96, v116 offset:1088
    ds_write_b32 v96, v212 offset:14400
    ds_write_b32 v242, v132 offset:27712
    s_mov_b64 exec, -1
    v_add_u32 v97, v97, v149
    v_and_b32 v242, -4, v97
    v_lshlrev_b32 v97, 2, v97
    s_mov_b64 exec, s[50:51]
    ds_write_b32 v97, v117 offset:1088
    ds_write_b32 v97, v213 offset:14400
    ds_write_b32 v242, v133 offset:27712
    s_mov_b64 exec, -1
    v_add_u32 v98, v98, v150
    v_and_b32 v242, -4, v98
    v_lshlrev_b32 v98, 2, v98
    s_mov_b64 exec, s[52:53]
    ds_write_b32 v98, v118 offset:1088
    ds_write_b32 v98, v214 offset:14400
    ds_write_b32 v242, v134 offset:27712
    s_mov_b64 exec, -1
    v_add_u32 v99, v99, v151
    v_and_b32 v242, -4, v99
    v_lshlrev_b32 v99, 2, v99
    s_mov_b64 exec, s[54:55]
    ds_write_b32 v99, v119 offset:1088
    ds_write_b32 v99, v215 offset:14400
    ds_write_b32 v242, v135 offset:27712
    s_mov_b64 exec, -1
    v_add_u32 v100, v100, v152
    v_and_b32 v242, -4, v100
    v_lshlrev_b32 v100, 2, v100
    s_mov_b64 exec, s[56:57]
    ds_write_b32 v100, v120 offset:1088
    ds_write_b32 v100, v216 offset:14400
    ds_write_b32 v242, v136 offset:27712
    s_mov_b64 exec, -1
    v_add_u32 v101, v101, v153
    v_and_b32 v242, -4, v101
    v_lshlrev_b32 v101, 2, v101
    s_mov_b64 exec, s[58:59]
    ds_write_b32 v101, v121 offset:1088
    ds_write_b32 v101, v217 offset:14400
    ds_write_b32 v242, v137 offset:27712
    s_mov_b64 exec, -1
    v_add_u32 v102, v102, v154
    v_and_b32 v242, -4, v102
    v_lshlrev_b32 v102, 2, v102
    s_mov_b64 exec, s[60:61]
    ds_write_b32 v102, v122 offset:1088
    ds_write_b32 v102, v218 offset:14400
    ds_write_b32 v242, v138 offset:27712
    s_mov_b64 exec, -1
    v_add_u32 v103, v103, v155
    v_and_b32 v242, -4, v103
    v_lshlrev_b32 v103, 2, v103
    s_mov_b64 exec, s[62:63]
    ds_write_b32 v103, v123 offset:1088
    ds_write_b32 v103, v219 offset:14400
    ds_write_b32 v242, v139 offset:27712
    s_mov_b64 exec, -1
    s_mov_b64 exec, s[64:65]
    s_cbranch_execz k_sskip_8
    v_lshlrev_b32 v140, 9, v140
    v_bfe_u32 v243, v124, 14, 12
    v_and_b32 v124, s90, v124
    v_add_lshl_u32 v243, v243, v208, 5
    v_lshlrev_b32 v124, 7, v124
    v_add_u32 v104, v104, v156
    v_and_b32 v242, -4, v104
    v_lshlrev_b32 v104, 2, v104
    ds_write_b32 v104, v124 offset:1088
    ds_write_b32 v104, v243 offset:14400
    ds_write_b32 v242, v140 offset:27712
k_sskip_8:
    s_mov_b64 exec, s[66:67]
    s_cbranch_execz k_sskip_9
    v_lshlrev_b32 v141, 9, v141
    v_bfe_u32 v243, v125, 14, 12
    v_and_b32 v125, s90, v125
    v_add_lshl_u32 v243, v243, v208, 5
    v_lshlrev_b32 v125, 7, v125
    v_add_u32 v105, v105, v157
    v_and_b32 v242, -4, v105
    v_lshlrev_b32 v105, 2, v105
    ds_write_b32 v105, v125 offset:1088
    ds_write_b32 v105, v243 offset:14400
    ds_write_b32 v242, v141 offset:27712
k_sskip_9:
    s_mov_b64 exec, s[68:69]
    s_cbranch_execz k_sskip_10
    v_lshlrev_b32 v142, 9, v142
    v_bfe_u32 v243, v126, 14, 12
    v_and_b32 v126, s90, v126
    v_add_lshl_u32 v243, v243, v208, 5
    v_lshlrev_b32 v126, 7, v126
    v_add_u32 v106, v106, v158
    v_and_b32 v242, -4, v106
    v_lshlrev_b32 v106, 2, v106
    ds_write_b32 v106, v126 offset:1088
    ds_write_b32 v106, v243 offset:14400
    ds_write_b32 v242, v142 offset:27712
k_sskip_10:
    s_mov_b64 exec, s[70:71]
    s_cbranch_execz k_sskip_11
    v_lshlrev_b32 v143, 9, v143
    v_bfe_u32 v243, v127, 14, 12
    v_and_b32 v127, s90, v127
    v_add_lshl_u32 v243, v243, v208, 5
    v_lshlrev_b32 v127, 7, v127
    v_add_u32 v107, v107, v159
    v_and_b32 v242, -4, v107
    v_lshlrev_b32 v107, 2, v107
    ds_write_b32 v107, v127 offset:1088
    ds_write_b32 v107, v243 offset:14400
    ds_write_b32 v242, v143 offset:27712
k_sskip_11:
    s_mov_b64 exec, s[72:73]
    s_cbranch_execz k_sskip_12
    v_lshlrev_b32 v144, 9, v144
    v_bfe_u32 v243, v128, 14, 12
    v_and_b32 v128, s90, v128
    v_add_lshl_u32 v243, v243, v209, 5
    v_lshlrev_b32 v128, 7, v128
    v_add_u32 v108, v108, v160
    v_and_b32 v242, -4, v108
    v_lshlrev_b32 v108, 2, v108
    ds_write_b32 v108, v128 offset:1088
    ds_write_b32 v108, v243 offset:14400
    ds_write_b32 v242, v144 offset:27712
k_sskip_12:
    s_mov_b64 exec, s[74:75]
    s_cbranch_execz k_sskip_13
    v_lshlrev_b32 v145, 9, v145
    v_bfe_u32 v243, v129, 14, 12
    v_and_b32 v129, s90, v129
    v_add_lshl_u32 v243, v243, v209, 5
    v_lshlrev_b32 v129, 7, v129
    v_add_u32 v109, v109, v161
    v_and_b32 v242, -4, v109
    v_lshlrev_b32 v109, 2, v109
    ds_write_b32 v109, v129 offset:1088
    ds_write_b32 v109, v243 offset:14400
    ds_write_b32 v242, v145 offset:27712
k_sskip_13:
    s_mov_b64 exec, s[76:77]
    s_cbranch_execz k_sskip_14
    v_lshlrev_b32 v146, 9, v146
    v_bfe_u32 v243, v130, 14, 12
    v_and_b32 v130, s90, v130
    v_add_lshl_u32 v243, v243, v209, 5
    v_lshlrev_b32 v130, 7, v130
    v_add_u32 v110, v110, v162
    v_and_b32 v242, -4, v110
    v_lshlrev_b32 v110, 2, v110
    ds_write_b32 v110, v130 offset:1088
    ds_write_b32 v110, v243 offset:14400
    ds_write_b32 v242, v146 offset:27712
k_sskip_14:
    s_mov_b64 exec, s[78:79]
    s_cbranch_execz k_sskip_15
    v_lshlrev_b32 v147, 9, v147
    v_bfe_u32 v243, v131, 14, 12
    v_and_b32 v131, s90, v131
    v_add_lshl_u32 v243, v243, v209, 5
    v_lshlrev_b32 v131, 7, v131
    v_add_u32 v111, v111, v163
    v_and_b32 v242, -4, v111
    v_lshlrev_b32 v111, 2, v111
    ds_write_b32 v111, v131 offset:1088
    ds_write_b32 v111, v243 offset:14400
    ds_write_b32 v242, v147 offset:27712
k_sskip_15:
    s_mov_b64 exec, -1
    s_bitcmp1_b32 s47, 1
    s_cbranch_scc1 k_w3
    s_bitcmp1_b32 s47, 2
    s_cbranch_scc1 k_w3
    s_or_b32 s47, s47, 4
    s_waitcnt vmcnt(0)
    v_lshlrev_b32 v14, 4, v1
    v_add_u32 v13, 103424, v14
    s_lshl_b32 s96, s42, 10
    v_add_u32 v13, s96, v13
    ds_write_b128 v13, v[16:19]
    ds_write_b128 v13, v[20:23] offset:8192
    s_cmp_lt_u32 s42, 4
    s_cbranch_scc0 k_w3
    ds_write_b128 v13, v[24:27] offset:16384
k_w3:
    s_mov_b32 m0, s86
    s_waitcnt vmcnt(0) lgkmcnt(0)
    s_barrier
k_main:
    s_lshr_b32 s90, s45, 3
    s_and_b32 s91, s45, 7
    s_cmp_lt_u32 s42, s91
    s_cselect_b32 s92, 1, 0
    s_add_u32 s89, s90, s92
    s_mul_i32 s96, s42, s90
    s_min_u32 s92, s42, s91
    s_add_u32 s96, s96, s92
    s_cmp_eq_u32 s89, 0
    s_cbranch_scc1 L_mnone_c
    s_sub_u32 s82, s89, 1
    s_lshl_b32 s93, s96, 3
    s_lshl_b32 s94, s89, 2
    v_lshrrev_b32 v2, 3, v1
    v_lshrrev_b32 v3, 2, v2
    v_and_b32 v4, 3, v2
    v_mul_u32_u24 v3, s94, v3
    v_add3_u32 v3, v3, v4, s93
    v_lshlrev_b32 v3, 4, v3
    v_add_u32 v225, 1088, v3
    v_lshrrev_b32 v2, 5, v1
    v_mul_u32_u24 v3, s94, v2
    v_add_u32 v3, s93, v3
    v_bfe_u32 v4, v1, 1, 4
    v_lshlrev_b32 v4, 2, v4
    v_lshl_add_u32 v4, v3, 4, v4
    v_add_u32 v226, 14400, v4
    v_lshlrev_b32 v4, 2, v3
    v_add_u32 v227, 27712, v4
    ds_read_b128 v[220:223], v225
    ds_read_b32 v224, v226
    ds_read_b128 v[228:231], v227
    s_lshl_b32 s95, s42, 11
    s_add_u32 s95, s95, 102400
    v_and_b32 v4, 31, v1
    v_lshlrev_b32 v4, 3, v4
    v_lshl_add_u32 v4, v2, 10, v4
    v_add_u32 v238, s95, v4
    v_and_b32 v236, 0xfffffbff, v236
    s_mov_b32 s10, 20480000
    s_mov_b32 s6, 1283120
    s_waitcnt lgkmcnt(0)
    v_add_u32 v220, v220, v232
    v_add_u32 v221, v221, v232
    v_add_u32 v222, v222, v232
    v_add_u32 v223, v223, v232
    v_add_u32 v224, v224, v233
    s_add_u32 m0, s87, 0
    s_nop 0
    buffer_load_dwordx4 v224, s[8:11], 0 offen nt lds
    s_mov_b32 m0, s86
    s_nop 0
    buffer_load_dwordx4 v220, s[4:7], s83 offen lds
    buffer_load_dwordx4 v221, s[4:7], s84 offen offset:1040 lds
    buffer_load_dwordx4 v222, s[4:7], s85 offen offset:2080 lds
    buffer_load_dwordx4 v223, s[4:7], 0 offen offset:3120 lds
    ds_read_b32 v224, v226 offset:64
    ds_read_b128 v[220:223], v225 offset:64
    s_bitcmp1_b32 s47, 1
    s_cbranch_scc1 k_wdone_c
    s_or_b32 s47, s47, 2
    v_lshlrev_b32 v14, 4, v1
    v_add_u32 v14, 103424, v14
    ds_read_b128 v[16:19], v14 offset:0
    ds_read_b128 v[20:23], v14 offset:1024
    ds_read_b128 v[24:27], v14 offset:2048
    ds_read_b128 v[28:31], v14 offset:3072
    ds_read_b128 v[32:35], v14 offset:4096
    ds_read_b128 v[36:39], v14 offset:5120
    ds_read_b128 v[40:43], v14 offset:6144
    ds_read_b128 v[44:47], v14 offset:7168
    ds_read_b128 v[48:51], v14 offset:8192
    ds_read_b128 v[52:55], v14 offset:9216
    ds_read_b128 v[56:59], v14 offset:10240
    ds_read_b128 v[60:63], v14 offset:11264
    ds_read_b128 v[64:67], v14 offset:12288
    ds_read_b128 v[68:71], v14 offset:13312
    ds_read_b128 v[72:75], v14 offset:14336
    ds_read_b128 v[76:79], v14 offset:15360
    ds_read_b128 v[80:83], v14 offset:16384
    ds_read_b128 v[84:87], v14 offset:17408
    ds_read_b128 v[88:91], v14 offset:18432
    ds_read_b128 v[92:95], v14 offset:19456
    s_waitcnt lgkmcnt(0)
    s_barrier
k_wdone_c:
    s_cmp_lt_u32 s42, 4
    s_cbranch_scc1 k_prep_later
    v_lshlrev_b32 v241, 2, v1
    ds_read_b32 v2, v241 offset:832
    ds_read_b32 v12, v241 offset:836
    ds_read_b32 v13, v241 offset:0
    v_lshlrev_b32 v14, 3, v1
    s_lshl_b32 s93, s42, 9
    s_add_u32 s93, s93, 31040
    v_add_u32 v14, s93, v14
    ds_read_b64 v[148:149], v14 offset:0
    ds_read_b64 v[150:151], v14 offset:4096
    ds_read_b64 v[152:153], v14 offset:8192
    ds_read_b64 v[154:155], v14 offset:12288
    ds_read_b64 v[156:157], v14 offset:16384
    s_lshr_b32 s90, s45, 3
    s_and_b32 s91, s45, 7
    v_lshrrev_b32 v3, 1, v1
    v_and_b32 v4, 1, v1
    v_cmp_gt_u32 vcc, s91, v3
    v_mul_u32_u24 v6, s90, v3
    v_min_u32 v7, s91, v3
    v_cndmask_b32_e64 v5, 0, 1, vcc
    v_add_u32 v5, s90, v5
    v_add_u32 v6, v6, v7
    v_lshlrev_b32 v6, 3, v6
    v_lshlrev_b32 v5, 2, v5
    v_mul_u32_u24 v7, v5, v4
    v_add_u32 v6, v6, v7
    v_add_u32 v7, v6, v5
    v_cmp_gt_u32 vcc, 16, v1
    v_mov_b32 v15, 0x7fffffff
    s_mov_b32 s99, 0xffff0000
    v_cndmask_b32 v6, v15, v6, vcc
    s_waitcnt lgkmcnt(0)
    v_sub_u32 v12, v12, v2
    v_sub_u32 v12, v12, v13
    v_cvt_f32_u32 v12, v12
    v_lshlrev_b32 v164, 16, v148
    v_and_b32 v172, s99, v148
    v_add_f32 v164, v164, v172
    v_lshlrev_b32 v165, 16, v149
    v_and_b32 v173, s99, v149
    v_add_f32 v165, v165, v173
    v_lshlrev_b32 v166, 16, v150
    v_and_b32 v174, s99, v150
    v_add_f32 v166, v166, v174
    v_lshlrev_b32 v167, 16, v151
    v_and_b32 v175, s99, v151
    v_add_f32 v167, v167, v175
    v_lshlrev_b32 v168, 16, v152
    v_and_b32 v176, s99, v152
    v_add_f32 v168, v168, v176
    v_lshlrev_b32 v169, 16, v153
    v_and_b32 v177, s99, v153
    v_add_f32 v169, v169, v177
    v_lshlrev_b32 v170, 16, v154
    v_and_b32 v178, s99, v154
    v_add_f32 v170, v170, v178
    v_lshlrev_b32 v171, 16, v155
    v_and_b32 v179, s99, v155
    v_add_f32 v171, v171, v179
    v_lshlrev_b32 v204, 16, v156
    v_and_b32 v180, s99, v156
    v_add_f32 v204, v204, v180
    v_lshlrev_b32 v205, 16, v157
    v_and_b32 v181, s99, v157
    v_add_f32 v205, v205, v181
    v_exp_f32 v172, v164
    v_exp_f32 v173, v165
    v_exp_f32 v174, v166
    v_exp_f32 v175, v167
    v_exp_f32 v176, v168
    v_exp_f32 v177, v169
    v_exp_f32 v178, v170
    v_exp_f32 v179, v171
    v_exp_f32 v180, v204
    v_exp_f32 v181, v205
    s_add_u32 s92, s42, 0
    s_add_u32 s93, s92, 1
    v_readlane_b32 s94, v2, s92
    v_readlane_b32 s95, v2, s93
    v_readlane_b32 s48, v12, s92
    v_fma_f32 v172, v172, s40, s40
    v_fma_f32 v173, v173, s40, s40
    s_lshr_b32 s94, s94, 2
    s_lshr_b32 s95, s95, 2
    v_rcp_f32 v172, v172
    v_rcp_f32 v173, v173
    v_cmp_gt_u32 vcc, s95, v6
    v_cmp_lt_u32 s[96:97], s94, v7
    v_mul_f32 v172, v164, v172
    v_mul_f32 v173, v165, v173
    s_and_b64 vcc, vcc, s[96:97]
    v_fma_f32 v244, -v172, s48, v244
    v_fma_f32 v245, -v173, s48, v245
    s_cmp_lt_u32 s94, s95
    s_cselect_b32 s58, vcc_lo, 0
    s_ff1_i32_b32 s94, s58
    s_add_u32 s95, s94, s92
    s_cmp_eq_u32 s58, 0
    s_cselect_b32 s95, 57, s95
    s_lshl_b32 s48, s95, 10
    s_add_u32 s94, s58, -1
    s_and_b32 s58, s58, s94
    s_ff1_i32_b32 s94, s58
    s_add_u32 s95, s94, s92
    s_cmp_eq_u32 s58, 0
    s_cselect_b32 s95, 57, s95
    s_lshl_b32 s53, s95, 10
    s_add_u32 s94, s58, -1
    s_and_b32 s58, s58, s94
    s_add_u32 s92, s42, 8
    s_add_u32 s93, s92, 1
    v_readlane_b32 s94, v2, s92
    v_readlane_b32 s95, v2, s93
    v_readlane_b32 s49, v12, s92
    v_fma_f32 v174, v174, s40, s40
    v_fma_f32 v175, v175, s40, s40
    s_lshr_b32 s94, s94, 2
    s_lshr_b32 s95, s95, 2
    v_rcp_f32 v174, v174
    v_rcp_f32 v175, v175
    v_cmp_gt_u32 vcc, s95, v6
    v_cmp_lt_u32 s[96:97], s94, v7
    v_mul_f32 v174, v166, v174
    v_mul_f32 v175, v167, v175
    s_and_b64 vcc, vcc, s[96:97]
    v_fma_f32 v246, -v174, s49, v246
    v_fma_f32 v247, -v175, s49, v247
    s_cmp_lt_u32 s94, s95
    s_cselect_b32 s59, vcc_lo, 0
    s_ff1_i32_b32 s94, s59
    s_add_u32 s95, s94, s92
    s_cmp_eq_u32 s59, 0
    s_cselect_b32 s95, 57, s95
    s_lshl_b32 s49, s95, 10
    s_add_u32 s94, s59, -1
    s_and_b32 s59, s59, s94
    s_ff1_i32_b32 s94, s59
    s_add_u32 s95, s94, s92
    s_cmp_eq_u32 s59, 0
    s_cselect_b32 s95, 57, s95
    s_lshl_b32 s54, s95, 10
    s_add_u32 s94, s59, -1
    s_and_b32 s59, s59, s94
    s_add_u32 s92, s42, 16
    s_add_u32 s93, s92, 1
    v_readlane_b32 s94, v2, s92
    v_readlane_b32 s95, v2, s93
    v_readlane_b32 s50, v12, s92
    v_fma_f32 v176, v176, s40, s40
    v_fma_f32 v177, v177, s40, s40
    s_lshr_b32 s94, s94, 2
    s_lshr_b32 s95, s95, 2
    v_rcp_f32 v176, v176
    v_rcp_f32 v177, v177
    v_cmp_gt_u32 vcc, s95, v6
    v_cmp_lt_u32 s[96:97], s94, v7
    v_mul_f32 v176, v168, v176
    v_mul_f32 v177, v169, v177
    s_and_b64 vcc, vcc, s[96:97]
    v_fma_f32 v248, -v176, s50, v248
    v_fma_f32 v249, -v177, s50, v249
    s_cmp_lt_u32 s94, s95
    s_cselect_b32 s60, vcc_lo, 0
    s_ff1_i32_b32 s94, s60
    s_add_u32 s95, s94, s92
    s_cmp_eq_u32 s60, 0
    s_cselect_b32 s95, 57, s95
    s_lshl_b32 s50, s95, 10
    s_add_u32 s94, s60, -1
    s_and_b32 s60, s60, s94
    s_ff1_i32_b32 s94, s60
    s_add_u32 s95, s94, s92
    s_cmp_eq_u32 s60, 0
    s_cselect_b32 s95, 57, s95
    s_lshl_b32 s55, s95, 10
    s_add_u32 s94, s60, -1
    s_and_b32 s60, s60, s94
    s_add_u32 s92, s42, 24
    s_add_u32 s93, s92, 1
    v_readlane_b32 s94, v2, s92
    v_readlane_b32 s95, v2, s93
    v_readlane_b32 s51, v12, s92
    v_fma_f32 v178, v178, s40, s40
    v_fma_f32 v179, v179, s40, s40
    s_lshr_b32 s94, s94, 2
    s_lshr_b32 s95, s95, 2
    v_rcp_f32 v178, v178
    v_rcp_f32 v179, v179
    v_cmp_gt_u32 vcc, s95, v6
    v_cmp_lt_u32 s[96:97], s94, v7
    v_mul_f32 v178, v170, v178
    v_mul_f32 v179, v171, v179
    s_and_b64 vcc, vcc, s[96:97]
    v_fma_f32 v250, -v178, s51, v250
    v_fma_f32 v251, -v179, s51, v251
    s_cmp_lt_u32 s94, s95
    s_cselect_b32 s61, vcc_lo, 0
    s_ff1_i32_b32 s94, s61
    s_add_u32 s95, s94, s92
    s_cmp_eq_u32 s61, 0
    s_cselect_b32 s95, 57, s95
    s_lshl_b32 s51, s95, 10
    s_add_u32 s94, s61, -1
    s_and_b32 s61, s61, s94
    s_ff1_i32_b32 s94, s61
    s_add_u32 s95, s94, s92
    s_cmp_eq_u32 s61, 0
    s_cselect_b32 s95, 57, s95
    s_lshl_b32 s56, s95, 10
    s_add_u32 s94, s61, -1
    s_and_b32 s61, s61, s94
    s_add_u32 s92, s42, 32
    s_add_u32 s93, s92, 1
    v_readlane_b32 s94, v2, s92
    v_readlane_b32 s95, v2, s93
    v_readlane_b32 s52, v12, s92
    v_fma_f32 v180, v180, s40, s40
    v_fma_f32 v181, v181, s40, s40
    s_lshr_b32 s94, s94, 2
    s_lshr_b32 s95, s95, 2
    v_rcp_f32 v180, v180
    v_rcp_f32 v181, v181
    v_cmp_gt_u32 vcc, s95, v6
    v_cmp_lt_u32 s[96:97], s94, v7
    v_mul_f32 v180, v204, v180
    v_mul_f32 v181, v205, v181
    s_and_b64 vcc, vcc, s[96:97]
    v_fma_f32 v252, -v180, s52, v252
    v_fma_f32 v253, -v181, s52, v253
    s_cmp_lt_u32 s94, s95
    s_cselect_b32 s62, vcc_lo, 0
    s_ff1_i32_b32 s94, s62
    s_add_u32 s95, s94, s92
    s_cmp_eq_u32 s62, 0
    s_cselect_b32 s95, 57, s95
    s_lshl_b32 s52, s95, 10
    s_add_u32 s94, s62, -1
    s_and_b32 s62, s62, s94
    s_ff1_i32_b32 s94, s62
    s_add_u32 s95, s94, s92
    s_cmp_eq_u32 s62, 0
    s_cselect_b32 s95, 57, s95
    s_lshl_b32 s57, s95, 10
    s_add_u32 s94, s62, -1
    s_and_b32 s62, s62, s94
k_prep_later:
    v_mov_b64 v[180:181], 0
    v_mov_b64 v[182:183], 0
    v_mov_b64 v[184:185], 0
    v_mov_b64 v[186:187], 0
    v_mov_b32 v239, v228
    v_lshl_add_u32 v240, v228, 1, v238
    v_add_u32 v208, v228, v237
    ds_read_b32 v188, v208 offset:0
    ds_read_b32 v190, v208 offset:128
    ds_read_b32 v192, v208 offset:256
    ds_read_b32 v194, v208 offset:384
    v_cmp_ne_u32 vcc, v231, v239
    s_waitcnt lgkmcnt(0)
    v_add_u32 v220, v220, v232
    v_add_u32 v221, v221, v232
    v_add_u32 v222, v222, v232
    v_add_u32 v223, v223, v232
    v_add_u32 v224, v224, v233
    s_waitcnt vmcnt(0)
    ds_read_b128 v[96:99], v234
    ds_read_b128 v[100:103], v234 offset:32
    ds_read_b128 v[104:107], v235 offset:64
    ds_read_b128 v[108:111], v235 offset:96
    ds_read_b128 v[112:115], v236
    s_cmp_gt_u32 s82, 0
    s_cselect_b32 s10, 20480000, 0
    s_add_u32 m0, s87, 1024
    s_nop 0
    buffer_load_dwordx4 v224, s[8:11], 0 offen nt lds
    s_mov_b32 m0, s86
    ds_read_b32 v224, v226 offset:128
    s_cmp_gt_u32 s82, 1
    s_cselect_b32 s10, 20480000, 0
    s_waitcnt lgkmcnt(0)
    v_add_u32 v224, v224, v233
    buffer_load_dwordx4 v220, s[4:7], s83 offen lds
    buffer_load_dwordx4 v221, s[4:7], s84 offen offset:1040 lds
    buffer_load_dwordx4 v222, s[4:7], s85 offen offset:2080 lds
    buffer_load_dwordx4 v223, s[4:7], 0 offen offset:3120 lds
    s_add_u32 m0, s87, 0
    s_nop 0
    buffer_load_dwordx4 v224, s[8:11], 0 offen nt lds
    s_mov_b32 m0, s86
    v_mfma_f32_32x32x16_bf16 v[116:131], v[96:99], v[16:19], 0
    v_mfma_f32_32x32x16_bf16 v[116:131], v[100:103], v[20:23], v[116:131]
    v_mfma_f32_32x32x16_bf16 v[116:131], v[104:107], v[24:27], v[116:131]
    v_mfma_f32_32x32x16_bf16 v[116:131], v[108:111], v[28:31], v[116:131]
    v_mfma_f32_32x32x16_bf16 v[116:131], v[112:115], v[32:35], v[116:131]
    v_add_u32 v225, 128, v225
    v_add_u32 v226, 192, v226
    v_add_u32 v227, 16, v227
    v_xor_b32 v236, 1024, v236
    s_add_u32 s88, s87, 1024
    v_mov_b32 v10, 0
    v_mov_b32 v11, 0
    s_cmp_lg_u32 s80, 0
    s_cbranch_scc1 L_S_safe
    s_cbranch_vccnz L_D_pair
L_F_pair:
    s_setprio 1
    v_mfma_f32_32x32x8_bf16 v[116:131], v[196:197], v[188:189], v[116:131]
    ds_read_b128 v[220:223], v225
    ds_read_b32 v224, v226
    ds_read_b128 v[228:231], v227
    v_add_u32 v225, 64, v225
    v_add_u32 v226, 64, v226
    v_add_u32 v227, 16, v227
    s_cmp_gt_u32 s82, 2
    s_cselect_b32 s10, 20480000, 0
    s_cmp_gt_u32 s82, 1
    s_cselect_b32 s6, 1283120, 0
    s_nop 3
    v_mfma_f32_32x32x16_bf16 v[132:147], v[96:99], v[36:39], 0
    v_exp_f32 v148, v116
    v_exp_f32 v149, v117
    v_exp_f32 v150, v118
    v_mfma_f32_32x32x16_bf16 v[132:147], v[100:103], v[40:43], v[132:147]
    v_exp_f32 v151, v119
    v_exp_f32 v152, v120
    v_exp_f32 v153, v121
    v_mfma_f32_32x32x16_bf16 v[132:147], v[104:107], v[44:47], v[132:147]
    v_exp_f32 v154, v122
    v_exp_f32 v155, v123
    v_exp_f32 v156, v124
    v_mfma_f32_32x32x16_bf16 v[132:147], v[108:111], v[48:51], v[132:147]
    v_exp_f32 v157, v125
    v_exp_f32 v158, v126
    v_exp_f32 v159, v127
    v_mfma_f32_32x32x16_bf16 v[132:147], v[112:115], v[52:55], v[132:147]
    v_exp_f32 v160, v128
    v_exp_f32 v161, v129
    v_exp_f32 v162, v130
    v_exp_f32 v163, v131
    v_pk_fma_f32 v[148:149], v[148:149], s[40:41], s[40:41]
    v_pk_fma_f32 v[150:151], v[150:151], s[40:41], s[40:41]
    v_pk_fma_f32 v[152:153], v[152:153], s[40:41], s[40:41]
    v_pk_fma_f32 v[154:155], v[154:155], s[40:41], s[40:41]
    v_pk_fma_f32 v[156:157], v[156:157], s[40:41], s[40:41]
    v_pk_fma_f32 v[158:159], v[158:159], s[40:41], s[40:41]
    v_pk_fma_f32 v[160:161], v[160:161], s[40:41], s[40:41]
    v_pk_fma_f32 v[162:163], v[162:163], s[40:41], s[40:41]
    v_pk_mul_f32 v[164:165], v[148:149], v[150:151]
    v_pk_mul_f32 v[166:167], v[152:153], v[154:155]
    v_pk_mul_f32 v[168:169], v[156:157], v[158:159]
    v_pk_mul_f32 v[170:171], v[160:161], v[162:163]
    v_pk_mul_f32 v[172:173], v[116:117], v[150:151]
    v_pk_mul_f32 v[174:175], v[120:121], v[154:155]
    v_pk_mul_f32 v[176:177], v[124:125], v[158:159]
    v_pk_mul_f32 v[178:179], v[128:129], v[162:163]
    v_pk_fma_f32 v[172:173], v[118:119], v[148:149], v[172:173]
    v_pk_fma_f32 v[174:175], v[122:123], v[152:153], v[174:175]
    v_pk_fma_f32 v[176:177], v[126:127], v[156:157], v[176:177]
    v_pk_fma_f32 v[178:179], v[130:131], v[160:161], v[178:179]
    v_pk_mul_f32 v[172:173], v[172:173], v[166:167]
    v_pk_mul_f32 v[176:177], v[176:177], v[170:171]
    v_pk_fma_f32 v[172:173], v[174:175], v[164:165], v[172:173]
    v_pk_fma_f32 v[176:177], v[178:179], v[168:169], v[176:177]
    v_pk_mul_f32 v[164:165], v[164:165], v[166:167]
    v_pk_mul_f32 v[168:169], v[168:169], v[170:171]
    v_mfma_f32_32x32x8_bf16 v[132:147], v[196:197], v[190:191], v[132:147]
    v_rcp_f32 v164, v164
    v_rcp_f32 v165, v165
    v_rcp_f32 v168, v168
    v_rcp_f32 v169, v169
    v_pk_fma_f32 v[180:181], v[172:173], v[164:165], v[180:181]
    v_pk_fma_f32 v[180:181], v[176:177], v[168:169], v[180:181]
    s_waitcnt lgkmcnt(0)
    v_cmp_ne_u32 vcc, v231, v239
    v_add_u32 v220, v220, v232
    v_add_u32 v221, v221, v232
    v_add_u32 v222, v222, v232
    v_mfma_f32_32x32x16_bf16 v[116:131], v[96:99], v[56:59], 0
    v_exp_f32 v148, v132
    v_exp_f32 v149, v133
    v_exp_f32 v150, v134
    v_mfma_f32_32x32x16_bf16 v[116:131], v[100:103], v[60:63], v[116:131]
    v_exp_f32 v151, v135
    v_exp_f32 v152, v136
    v_exp_f32 v153, v137
    v_mfma_f32_32x32x16_bf16 v[116:131], v[104:107], v[64:67], v[116:131]
    v_exp_f32 v154, v138
    v_exp_f32 v155, v139
    v_exp_f32 v156, v140
    v_mfma_f32_32x32x16_bf16 v[116:131], v[108:111], v[68:71], v[116:131]
    v_exp_f32 v157, v141
    v_exp_f32 v158, v142
    v_exp_f32 v159, v143
    v_mfma_f32_32x32x16_bf16 v[116:131], v[112:115], v[72:75], v[116:131]
    v_exp_f32 v160, v144
    v_exp_f32 v161, v145
    v_exp_f32 v162, v146
    v_exp_f32 v163, v147
    v_pk_fma_f32 v[148:149], v[148:149], s[40:41], s[40:41]
    v_pk_fma_f32 v[150:151], v[150:151], s[40:41], s[40:41]
    v_pk_fma_f32 v[152:153], v[152:153], s[40:41], s[40:41]
    v_pk_fma_f32 v[154:155], v[154:155], s[40:41], s[40:41]
    v_pk_fma_f32 v[156:157], v[156:157], s[40:41], s[40:41]
    v_pk_fma_f32 v[158:159], v[158:159], s[40:41], s[40:41]
    v_pk_fma_f32 v[160:161], v[160:161], s[40:41], s[40:41]
    v_pk_fma_f32 v[162:163], v[162:163], s[40:41], s[40:41]
    v_pk_mul_f32 v[164:165], v[148:149], v[150:151]
    v_pk_mul_f32 v[166:167], v[152:153], v[154:155]
    v_pk_mul_f32 v[168:169], v[156:157], v[158:159]
    v_pk_mul_f32 v[170:171], v[160:161], v[162:163]
    v_pk_mul_f32 v[172:173], v[132:133], v[150:151]
    v_pk_mul_f32 v[174:175], v[136:137], v[154:155]
    v_pk_mul_f32 v[176:177], v[140:141], v[158:159]
    v_pk_mul_f32 v[178:179], v[144:145], v[162:163]
    v_pk_fma_f32 v[172:173], v[134:135], v[148:149], v[172:173]
    v_pk_fma_f32 v[174:175], v[138:139], v[152:153], v[174:175]
    v_pk_fma_f32 v[176:177], v[142:143], v[156:157], v[176:177]
    v_pk_fma_f32 v[178:179], v[146:147], v[160:161], v[178:179]
    v_pk_mul_f32 v[172:173], v[172:173], v[166:167]
    v_pk_mul_f32 v[176:177], v[176:177], v[170:171]
    v_pk_fma_f32 v[172:173], v[174:175], v[164:165], v[172:173]
    v_pk_fma_f32 v[176:177], v[178:179], v[168:169], v[176:177]
    v_pk_mul_f32 v[164:165], v[164:165], v[166:167]
    v_pk_mul_f32 v[168:169], v[168:169], v[170:171]
    v_mfma_f32_32x32x8_bf16 v[116:131], v[196:197], v[192:193], v[116:131]
    v_rcp_f32 v164, v164
    v_rcp_f32 v165, v165
    v_rcp_f32 v168, v168
    v_rcp_f32 v169, v169
    v_pk_fma_f32 v[182:183], v[172:173], v[164:165], v[182:183]
    v_pk_fma_f32 v[182:183], v[176:177], v[168:169], v[182:183]
    v_add_u32 v223, v223, v232
    v_add_u32 v224, v224, v233
    v_mfma_f32_32x32x16_bf16 v[132:147], v[96:99], v[76:79], 0
    s_nop 2
    v_exp_f32 v148, v116
    v_exp_f32 v149, v117
    v_exp_f32 v150, v118
    v_mfma_f32_32x32x16_bf16 v[132:147], v[100:103], v[80:83], v[132:147]
    v_exp_f32 v151, v119
    v_exp_f32 v152, v120
    v_exp_f32 v153, v121
    v_mfma_f32_32x32x16_bf16 v[132:147], v[104:107], v[84:87], v[132:147]
    v_exp_f32 v154, v122
    v_exp_f32 v155, v123
    v_exp_f32 v156, v124
    v_mfma_f32_32x32x16_bf16 v[132:147], v[108:111], v[88:91], v[132:147]
    v_exp_f32 v157, v125
    v_exp_f32 v158, v126
    v_exp_f32 v159, v127
    v_mfma_f32_32x32x16_bf16 v[132:147], v[112:115], v[92:95], v[132:147]
    v_exp_f32 v160, v128
    v_exp_f32 v161, v129
    v_exp_f32 v162, v130
    v_exp_f32 v163, v131
    v_pk_fma_f32 v[148:149], v[148:149], s[40:41], s[40:41]
    s_waitcnt vmcnt(1)
    ds_read_b128 v[96:99], v234
    v_pk_fma_f32 v[150:151], v[150:151], s[40:41], s[40:41]
    v_pk_fma_f32 v[152:153], v[152:153], s[40:41], s[40:41]
    v_pk_fma_f32 v[154:155], v[154:155], s[40:41], s[40:41]
    v_pk_fma_f32 v[156:157], v[156:157], s[40:41], s[40:41]
    v_pk_fma_f32 v[158:159], v[158:159], s[40:41], s[40:41]
    ds_read_b128 v[100:103], v234 offset:32
    v_pk_fma_f32 v[160:161], v[160:161], s[40:41], s[40:41]
    v_pk_fma_f32 v[162:163], v[162:163], s[40:41], s[40:41]
    v_pk_mul_f32 v[164:165], v[148:149], v[150:151]
    v_pk_mul_f32 v[166:167], v[152:153], v[154:155]
    v_pk_mul_f32 v[168:169], v[156:157], v[158:159]
    ds_read_b128 v[104:107], v235 offset:64
    v_pk_mul_f32 v[170:171], v[160:161], v[162:163]
    v_pk_mul_f32 v[172:173], v[116:117], v[150:151]
    v_pk_mul_f32 v[174:175], v[120:121], v[154:155]
    v_pk_mul_f32 v[176:177], v[124:125], v[158:159]
    v_pk_mul_f32 v[178:179], v[128:129], v[162:163]
    ds_read_b128 v[108:111], v235 offset:96
    v_pk_fma_f32 v[172:173], v[118:119], v[148:149], v[172:173]
    v_pk_fma_f32 v[174:175], v[122:123], v[152:153], v[174:175]
    v_pk_fma_f32 v[176:177], v[126:127], v[156:157], v[176:177]
    v_pk_fma_f32 v[178:179], v[130:131], v[160:161], v[178:179]
    v_pk_mul_f32 v[172:173], v[172:173], v[166:167]
    ds_read_b128 v[112:115], v236
    v_pk_mul_f32 v[176:177], v[176:177], v[170:171]
    v_pk_fma_f32 v[172:173], v[174:175], v[164:165], v[172:173]
    v_pk_fma_f32 v[176:177], v[178:179], v[168:169], v[176:177]
    v_pk_mul_f32 v[164:165], v[164:165], v[166:167]
    v_pk_mul_f32 v[168:169], v[168:169], v[170:171]
    v_mfma_f32_32x32x8_bf16 v[132:147], v[196:197], v[194:195], v[132:147]
    v_rcp_f32 v164, v164
    v_rcp_f32 v165, v165
    v_rcp_f32 v168, v168
    v_rcp_f32 v169, v169
    v_pk_fma_f32 v[184:185], v[172:173], v[164:165], v[184:185]
    v_pk_fma_f32 v[184:185], v[176:177], v[168:169], v[184:185]
    s_setprio 0
    s_waitcnt lgkmcnt(0)
    buffer_load_dwordx4 v220, s[4:7], s83 offen lds
    buffer_load_dwordx4 v221, s[4:7], s84 offen offset:1040 lds
    buffer_load_dwordx4 v222, s[4:7], s85 offen offset:2080 lds
    v_mfma_f32_32x32x16_bf16 v[116:131], v[96:99], v[16:19], 0
    v_exp_f32 v148, v132
    v_exp_f32 v149, v133
    v_exp_f32 v150, v134
    v_mfma_f32_32x32x16_bf16 v[116:131], v[100:103], v[20:23], v[116:131]
    v_exp_f32 v151, v135
    v_exp_f32 v152, v136
    v_exp_f32 v153, v137
    v_mfma_f32_32x32x16_bf16 v[116:131], v[104:107], v[24:27], v[116:131]
    v_exp_f32 v154, v138
    v_exp_f32 v155, v139
    v_exp_f32 v156, v140
    v_mfma_f32_32x32x16_bf16 v[116:131], v[108:111], v[28:31], v[116:131]
    v_exp_f32 v157, v141
    v_exp_f32 v158, v142
    v_exp_f32 v159, v143
    v_mfma_f32_32x32x16_bf16 v[116:131], v[112:115], v[32:35], v[116:131]
    v_exp_f32 v160, v144
    v_exp_f32 v161, v145
    v_exp_f32 v162, v146
    v_exp_f32 v163, v147
    v_pk_fma_f32 v[148:149], v[148:149], s[40:41], s[40:41]
    buffer_load_dwordx4 v223, s[4:7], 0 offen offset:3120 lds
    v_pk_fma_f32 v[150:151], v[150:151], s[40:41], s[40:41]
    v_pk_fma_f32 v[152:153], v[152:153], s[40:41], s[40:41]
    v_pk_fma_f32 v[154:155], v[154:155], s[40:41], s[40:41]
    v_pk_fma_f32 v[156:157], v[156:157], s[40:41], s[40:41]
    v_pk_fma_f32 v[158:159], v[158:159], s[40:41], s[40:41]
    v_pk_fma_f32 v[160:161], v[160:161], s[40:41], s[40:41]
    v_pk_fma_f32 v[162:163], v[162:163], s[40:41], s[40:41]
    v_pk_mul_f32 v[164:165], v[148:149], v[150:151]
    v_pk_mul_f32 v[166:167], v[152:153], v[154:155]
    v_pk_mul_f32 v[168:169], v[156:157], v[158:159]
    v_pk_mul_f32 v[170:171], v[160:161], v[162:163]
    v_pk_mul_f32 v[172:173], v[132:133], v[150:151]
    s_mov_b32 m0, s88
    s_xor_b32 s88, s88, 1024
    buffer_load_dwordx4 v224, s[8:11], 0 offen nt lds
    s_mov_b32 m0, s86
    v_pk_mul_f32 v[174:175], v[136:137], v[154:155]
    v_pk_mul_f32 v[176:177], v[140:141], v[158:159]
    v_pk_mul_f32 v[178:179], v[144:145], v[162:163]
    v_pk_fma_f32 v[172:173], v[134:135], v[148:149], v[172:173]
    v_pk_fma_f32 v[174:175], v[138:139], v[152:153], v[174:175]
    v_pk_fma_f32 v[176:177], v[142:143], v[156:157], v[176:177]
    v_pk_fma_f32 v[178:179], v[146:147], v[160:161], v[178:179]
    v_pk_mul_f32 v[172:173], v[172:173], v[166:167]
    v_pk_mul_f32 v[176:177], v[176:177], v[170:171]
    v_pk_fma_f32 v[172:173], v[174:175], v[164:165], v[172:173]
    v_pk_fma_f32 v[176:177], v[178:179], v[168:169], v[176:177]
    v_pk_mul_f32 v[164:165], v[164:165], v[166:167]
    v_pk_mul_f32 v[168:169], v[168:169], v[170:171]
    v_rcp_f32 v164, v164
    v_xor_b32 v236, 1024, v236
    v_rcp_f32 v165, v165
    v_rcp_f32 v168, v168
    v_rcp_f32 v169, v169
    v_pk_fma_f32 v[186:187], v[172:173], v[164:165], v[186:187]
    v_pk_fma_f32 v[186:187], v[176:177], v[168:169], v[186:187]
    s_sub_u32 s82, s82, 1
    s_cbranch_scc1 L_fin_pair
    s_cbranch_vccz L_F_pair
L_D_pair:
    v_cmp_ne_u32 s[90:91], v228, v239
    v_cmp_ne_u32 s[92:93], v229, v228
    v_cmp_ne_u32 s[94:95], v230, v229
    v_cmp_ne_u32 s[96:97], v231, v230
    s_mov_b32 s98, 0
    s_cmp_lg_u64 s[96:97], 0
    s_addc_u32 s98, s98, s98
    s_cmp_lg_u64 s[94:95], 0
    s_addc_u32 s98, s98, s98
    s_cmp_lg_u64 s[92:93], 0
    s_addc_u32 s98, s98, s98
    s_cmp_lg_u64 s[90:91], 0
    s_addc_u32 s98, s98, s98
    s_cmp_eq_u32 s98, 2
    s_cbranch_scc1 L_T1_pair
    s_cmp_eq_u32 s98, 4
    s_cbranch_scc1 L_T2_pair
    s_cmp_eq_u32 s98, 8
    s_cbranch_scc1 L_T3_pair
    s_cmp_eq_u32 s98, 1
    s_cbranch_scc0 L_S_pair
    v_add_u32 v208, v231, v237
    ds_write_b64 v240, v[180:181] offset:0
    ds_write_b64 v240, v[182:183] offset:256
    ds_write_b64 v240, v[184:185] offset:512
    ds_write_b64 v240, v[186:187] offset:768
    ds_read_b32 v188, v208 offset:0
    ds_read_b32 v190, v208 offset:128
    ds_read_b32 v192, v208 offset:256
    ds_read_b32 v194, v208 offset:384
    v_cndmask_b32_e64 v212, 1.0, 0, s[90:91]
    v_lshl_add_u32 v240, v231, 1, v238
    v_mov_b32 v239, v231
    v_pk_mul_f32 v[180:181], v[180:181], v[212:213] op_sel_hi:[1,0]
    v_pk_mul_f32 v[182:183], v[182:183], v[212:213] op_sel_hi:[1,0]
    v_pk_mul_f32 v[184:185], v[184:185], v[212:213] op_sel_hi:[1,0]
    v_pk_mul_f32 v[186:187], v[186:187], v[212:213] op_sel_hi:[1,0]
    s_waitcnt lgkmcnt(0)
    s_branch L_F_pair
L_T1_pair:
    s_setprio 1
    v_add_u32 v208, v231, v237
    ds_read_b32 v189, v208 offset:0
    ds_read_b32 v191, v208 offset:128
    ds_read_b32 v193, v208 offset:256
    ds_read_b32 v195, v208 offset:384
    s_and_b32 s98, s92, 0xffffff00
    s_and_b32 s99, s93, 0xffffff00
    v_cndmask_b32_e64 v212, 1.0, 0, s[92:93]
    v_mov_b32 v213, v240
    v_cndmask_b32_e64 v8, v196, 0, s[98:99]
    v_cndmask_b32_e64 v9, 0, v196, s[98:99]
    v_lshl_add_u32 v240, v231, 1, v238
    v_mov_b32 v239, v231
    ds_read_b128 v[220:223], v225
    ds_read_b32 v224, v226
    s_waitcnt lgkmcnt(2)
    v_mfma_f32_32x32x8_bf16 v[116:131], v[8:9], v[188:189], v[116:131]
    ds_read_b128 v[228:231], v227
    v_add_u32 v225, 64, v225
    v_add_u32 v226, 64, v226
    v_add_u32 v227, 16, v227
    s_cmp_gt_u32 s82, 2
    s_cselect_b32 s10, 20480000, 0
    s_cmp_gt_u32 s82, 1
    s_cselect_b32 s6, 1283120, 0
    s_nop 5
    v_mfma_f32_32x32x16_bf16 v[132:147], v[96:99], v[36:39], 0
    v_exp_f32 v148, v116
    v_exp_f32 v149, v117
    v_exp_f32 v150, v118
    v_mfma_f32_32x32x16_bf16 v[132:147], v[100:103], v[40:43], v[132:147]
    v_exp_f32 v151, v119
    v_exp_f32 v152, v120
    v_exp_f32 v153, v121
    v_mfma_f32_32x32x16_bf16 v[132:147], v[104:107], v[44:47], v[132:147]
    v_exp_f32 v154, v122
    v_exp_f32 v155, v123
    v_exp_f32 v156, v124
    v_mfma_f32_32x32x16_bf16 v[132:147], v[108:111], v[48:51], v[132:147]
    v_exp_f32 v157, v125
    v_exp_f32 v158, v126
    v_exp_f32 v159, v127
    v_mfma_f32_32x32x16_bf16 v[132:147], v[112:115], v[52:55], v[132:147]
    v_exp_f32 v160, v128
    v_exp_f32 v161, v129
    v_exp_f32 v162, v130
    v_exp_f32 v163, v131
    v_pk_fma_f32 v[148:149], v[148:149], s[40:41], s[40:41]
    v_pk_fma_f32 v[150:151], v[150:151], s[40:41], s[40:41]
    v_pk_fma_f32 v[152:153], v[152:153], s[40:41], s[40:41]
    v_pk_fma_f32 v[154:155], v[154:155], s[40:41], s[40:41]
    v_pk_fma_f32 v[156:157], v[156:157], s[40:41], s[40:41]
    v_pk_fma_f32 v[158:159], v[158:159], s[40:41], s[40:41]
    v_pk_fma_f32 v[160:161], v[160:161], s[40:41], s[40:41]
    v_pk_fma_f32 v[162:163], v[162:163], s[40:41], s[40:41]
    v_pk_mul_f32 v[164:165], v[148:149], v[150:151]
    v_pk_mul_f32 v[166:167], v[152:153], v[154:155]
    v_pk_mul_f32 v[168:169], v[156:157], v[158:159]
    v_pk_mul_f32 v[170:171], v[160:161], v[162:163]
    v_pk_mul_f32 v[172:173], v[116:117], v[150:151]
    v_pk_mul_f32 v[174:175], v[120:121], v[154:155]
    v_pk_mul_f32 v[176:177], v[124:125], v[158:159]
    v_pk_mul_f32 v[178:179], v[128:129], v[162:163]
    v_pk_fma_f32 v[172:173], v[118:119], v[148:149], v[172:173]
    v_pk_fma_f32 v[174:175], v[122:123], v[152:153], v[174:175]
    v_pk_fma_f32 v[176:177], v[126:127], v[156:157], v[176:177]
    v_pk_fma_f32 v[178:179], v[130:131], v[160:161], v[178:179]
    v_pk_mul_f32 v[176:177], v[176:177], v[170:171]
    v_pk_fma_f32 v[176:177], v[178:179], v[168:169], v[176:177]
    v_pk_mul_f32 v[168:169], v[168:169], v[170:171]
    v_mfma_f32_32x32x8_bf16 v[132:147], v[8:9], v[190:191], v[132:147]
    v_rcp_f32 v164, v164
    v_rcp_f32 v165, v165
    v_rcp_f32 v166, v166
    v_rcp_f32 v167, v167
    v_rcp_f32 v168, v168
    v_rcp_f32 v169, v169
    v_pk_fma_f32 v[180:181], v[172:173], v[164:165], v[180:181]
    v_pk_mul_f32 v[174:175], v[174:175], v[166:167]
    ds_write_b64 v213, v[180:181] offset:0
    v_pk_fma_f32 v[180:181], v[180:181], v[212:213], v[174:175] op_sel_hi:[1,0,1]
    v_pk_fma_f32 v[180:181], v[176:177], v[168:169], v[180:181]
    s_waitcnt lgkmcnt(0)
    v_cmp_ne_u32 vcc, v231, v239
    v_add_u32 v220, v220, v232
    v_add_u32 v221, v221, v232
    v_add_u32 v222, v222, v232
    v_mfma_f32_32x32x16_bf16 v[116:131], v[96:99], v[56:59], 0
    v_exp_f32 v148, v132
    v_exp_f32 v149, v133
    v_exp_f32 v150, v134
    v_mfma_f32_32x32x16_bf16 v[116:131], v[100:103], v[60:63], v[116:131]
    v_exp_f32 v151, v135
    v_exp_f32 v152, v136
    v_exp_f32 v153, v137
    v_mfma_f32_32x32x16_bf16 v[116:131], v[104:107], v[64:67], v[116:131]
    v_exp_f32 v154, v138
    v_exp_f32 v155, v139
    v_exp_f32 v156, v140
    v_mfma_f32_32x32x16_bf16 v[116:131], v[108:111], v[68:71], v[116:131]
    v_exp_f32 v157, v141
    v_exp_f32 v158, v142
    v_exp_f32 v159, v143
    v_mfma_f32_32x32x16_bf16 v[116:131], v[112:115], v[72:75], v[116:131]
    v_exp_f32 v160, v144
    v_exp_f32 v161, v145
    v_exp_f32 v162, v146
    v_exp_f32 v163, v147
    v_pk_fma_f32 v[148:149], v[148:149], s[40:41], s[40:41]
    v_pk_fma_f32 v[150:151], v[150:151], s[40:41], s[40:41]
    v_pk_fma_f32 v[152:153], v[152:153], s[40:41], s[40:41]
    v_pk_fma_f32 v[154:155], v[154:155], s[40:41], s[40:41]
    v_pk_fma_f32 v[156:157], v[156:157], s[40:41], s[40:41]
    v_pk_fma_f32 v[158:159], v[158:159], s[40:41], s[40:41]
    v_pk_fma_f32 v[160:161], v[160:161], s[40:41], s[40:41]
    v_pk_fma_f32 v[162:163], v[162:163], s[40:41], s[40:41]
    v_pk_mul_f32 v[164:165], v[148:149], v[150:151]
    v_pk_mul_f32 v[166:167], v[152:153], v[154:155]
    v_pk_mul_f32 v[168:169], v[156:157], v[158:159]
    v_pk_mul_f32 v[170:171], v[160:161], v[162:163]
    v_pk_mul_f32 v[172:173], v[132:133], v[150:151]
    v_pk_mul_f32 v[174:175], v[136:137], v[154:155]
    v_pk_mul_f32 v[176:177], v[140:141], v[158:159]
    v_pk_mul_f32 v[178:179], v[144:145], v[162:163]
    v_pk_fma_f32 v[172:173], v[134:135], v[148:149], v[172:173]
    v_pk_fma_f32 v[174:175], v[138:139], v[152:153], v[174:175]
    v_pk_fma_f32 v[176:177], v[142:143], v[156:157], v[176:177]
    v_pk_fma_f32 v[178:179], v[146:147], v[160:161], v[178:179]
    v_pk_mul_f32 v[176:177], v[176:177], v[170:171]
    v_pk_fma_f32 v[176:177], v[178:179], v[168:169], v[176:177]
    v_pk_mul_f32 v[168:169], v[168:169], v[170:171]
    v_mfma_f32_32x32x8_bf16 v[116:131], v[8:9], v[192:193], v[116:131]
    v_rcp_f32 v164, v164
    v_rcp_f32 v165, v165
    v_rcp_f32 v166, v166
    v_rcp_f32 v167, v167
    v_rcp_f32 v168, v168
    v_rcp_f32 v169, v169
    v_pk_fma_f32 v[182:183], v[172:173], v[164:165], v[182:183]
    v_pk_mul_f32 v[174:175], v[174:175], v[166:167]
    ds_write_b64 v213, v[182:183] offset:256
    v_pk_fma_f32 v[182:183], v[182:183], v[212:213], v[174:175] op_sel_hi:[1,0,1]
    v_pk_fma_f32 v[182:183], v[176:177], v[168:169], v[182:183]
    v_add_u32 v223, v223, v232
    v_add_u32 v224, v224, v233
    v_mfma_f32_32x32x16_bf16 v[132:147], v[96:99], v[76:79], 0
    v_exp_f32 v148, v116
    v_exp_f32 v149, v117
    v_exp_f32 v150, v118
    v_mfma_f32_32x32x16_bf16 v[132:147], v[100:103], v[80:83], v[132:147]
    v_exp_f32 v151, v119
    v_exp_f32 v152, v120
    v_exp_f32 v153, v121
    v_mfma_f32_32x32x16_bf16 v[132:147], v[104:107], v[84:87], v[132:147]
    v_exp_f32 v154, v122
    v_exp_f32 v155, v123
    v_exp_f32 v156, v124
    v_mfma_f32_32x32x16_bf16 v[132:147], v[108:111], v[88:91], v[132:147]
    v_exp_f32 v157, v125
    v_exp_f32 v158, v126
    v_exp_f32 v159, v127
    v_mfma_f32_32x32x16_bf16 v[132:147], v[112:115], v[92:95], v[132:147]
    v_exp_f32 v160, v128
    v_exp_f32 v161, v129
    v_exp_f32 v162, v130
    v_exp_f32 v163, v131
    v_pk_fma_f32 v[148:149], v[148:149], s[40:41], s[40:41]
    s_waitcnt vmcnt(1)
    ds_read_b128 v[96:99], v234
    v_pk_fma_f32 v[150:151], v[150:151], s[40:41], s[40:41]
    v_pk_fma_f32 v[152:153], v[152:153], s[40:41], s[40:41]
    v_pk_fma_f32 v[154:155], v[154:155], s[40:41], s[40:41]
    v_pk_fma_f32 v[156:157], v[156:157], s[40:41], s[40:41]
    ds_read_b128 v[100:103], v234 offset:32
    v_pk_fma_f32 v[158:159], v[158:159], s[40:41], s[40:41]
    v_pk_fma_f32 v[160:161], v[160:161], s[40:41], s[40:41]
    v_pk_fma_f32 v[162:163], v[162:163], s[40:41], s[40:41]
    v_pk_mul_f32 v[164:165], v[148:149], v[150:151]
    ds_read_b128 v[104:107], v235 offset:64
    v_pk_mul_f32 v[166:167], v[152:153], v[154:155]
    v_pk_mul_f32 v[168:169], v[156:157], v[158:159]
    v_pk_mul_f32 v[170:171], v[160:161], v[162:163]
    v_pk_mul_f32 v[172:173], v[116:117], v[150:151]
    v_pk_mul_f32 v[174:175], v[120:121], v[154:155]
    ds_read_b128 v[108:111], v235 offset:96
    v_pk_mul_f32 v[176:177], v[124:125], v[158:159]
    v_pk_mul_f32 v[178:179], v[128:129], v[162:163]
    v_pk_fma_f32 v[172:173], v[118:119], v[148:149], v[172:173]
    v_pk_fma_f32 v[174:175], v[122:123], v[152:153], v[174:175]
    ds_read_b128 v[112:115], v236
    v_pk_fma_f32 v[176:177], v[126:127], v[156:157], v[176:177]
    v_pk_fma_f32 v[178:179], v[130:131], v[160:161], v[178:179]
    v_pk_mul_f32 v[176:177], v[176:177], v[170:171]
    v_pk_fma_f32 v[176:177], v[178:179], v[168:169], v[176:177]
    v_pk_mul_f32 v[168:169], v[168:169], v[170:171]
    v_mfma_f32_32x32x8_bf16 v[132:147], v[8:9], v[194:195], v[132:147]
    v_rcp_f32 v164, v164
    v_rcp_f32 v165, v165
    v_rcp_f32 v166, v166
    v_rcp_f32 v167, v167
    v_rcp_f32 v168, v168
    v_rcp_f32 v169, v169
    v_pk_fma_f32 v[184:185], v[172:173], v[164:165], v[184:185]
    v_pk_mul_f32 v[174:175], v[174:175], v[166:167]
    ds_write_b64 v213, v[184:185] offset:512
    v_pk_fma_f32 v[184:185], v[184:185], v[212:213], v[174:175] op_sel_hi:[1,0,1]
    v_pk_fma_f32 v[184:185], v[176:177], v[168:169], v[184:185]
    s_setprio 0
    s_waitcnt lgkmcnt(0)
    buffer_load_dwordx4 v220, s[4:7], s83 offen lds
    buffer_load_dwordx4 v221, s[4:7], s84 offen offset:1040 lds
    buffer_load_dwordx4 v222, s[4:7], s85 offen offset:2080 lds
    v_mfma_f32_32x32x16_bf16 v[116:131], v[96:99], v[16:19], 0
    v_exp_f32 v148, v132
    v_exp_f32 v149, v133
    v_exp_f32 v150, v134
    v_mfma_f32_32x32x16_bf16 v[116:131], v[100:103], v[20:23], v[116:131]
    v_exp_f32 v151, v135
    v_exp_f32 v152, v136
    v_exp_f32 v153, v137
    v_mfma_f32_32x32x16_bf16 v[116:131], v[104:107], v[24:27], v[116:131]
    v_exp_f32 v154, v138
    v_exp_f32 v155, v139
    v_exp_f32 v156, v140
    v_mfma_f32_32x32x16_bf16 v[116:131], v[108:111], v[28:31], v[116:131]
    v_exp_f32 v157, v141
    v_exp_f32 v158, v142
    v_exp_f32 v159, v143
    v_mfma_f32_32x32x16_bf16 v[116:131], v[112:115], v[32:35], v[116:131]
    v_exp_f32 v160, v144
    v_exp_f32 v161, v145
    v_exp_f32 v162, v146
    v_exp_f32 v163, v147
    v_pk_fma_f32 v[148:149], v[148:149], s[40:41], s[40:41]
    buffer_load_dwordx4 v223, s[4:7], 0 offen offset:3120 lds
    v_pk_fma_f32 v[150:151], v[150:151], s[40:41], s[40:41]
    v_pk_fma_f32 v[152:153], v[152:153], s[40:41], s[40:41]
    v_pk_fma_f32 v[154:155], v[154:155], s[40:41], s[40:41]
    v_pk_fma_f32 v[156:157], v[156:157], s[40:41], s[40:41]
    v_pk_fma_f32 v[158:159], v[158:159], s[40:41], s[40:41]
    v_pk_fma_f32 v[160:161], v[160:161], s[40:41], s[40:41]
    v_pk_fma_f32 v[162:163], v[162:163], s[40:41], s[40:41]
    v_pk_mul_f32 v[164:165], v[148:149], v[150:151]
    v_pk_mul_f32 v[166:167], v[152:153], v[154:155]
    v_pk_mul_f32 v[168:169], v[156:157], v[158:159]
    v_pk_mul_f32 v[170:171], v[160:161], v[162:163]
    s_mov_b32 m0, s88
    s_xor_b32 s88, s88, 1024
    buffer_load_dwordx4 v224, s[8:11], 0 offen nt lds
    s_mov_b32 m0, s86
    v_pk_mul_f32 v[172:173], v[132:133], v[150:151]
    v_pk_mul_f32 v[174:175], v[136:137], v[154:155]
    v_pk_mul_f32 v[176:177], v[140:141], v[158:159]
    v_pk_mul_f32 v[178:179], v[144:145], v[162:163]
    v_pk_fma_f32 v[172:173], v[134:135], v[148:149], v[172:173]
    v_pk_fma_f32 v[174:175], v[138:139], v[152:153], v[174:175]
    v_pk_fma_f32 v[176:177], v[142:143], v[156:157], v[176:177]
    v_pk_fma_f32 v[178:179], v[146:147], v[160:161], v[178:179]
    v_pk_mul_f32 v[176:177], v[176:177], v[170:171]
    v_pk_fma_f32 v[176:177], v[178:179], v[168:169], v[176:177]
    v_pk_mul_f32 v[168:169], v[168:169], v[170:171]
    v_rcp_f32 v164, v164
    v_xor_b32 v236, 1024, v236
    v_rcp_f32 v165, v165
    v_mov_b32 v188, v189
    v_rcp_f32 v166, v166
    v_mov_b32 v190, v191
    v_rcp_f32 v167, v167
    v_mov_b32 v192, v193
    v_rcp_f32 v168, v168
    v_mov_b32 v194, v195
    v_rcp_f32 v169, v169
    v_pk_fma_f32 v[186:187], v[172:173], v[164:165], v[186:187]
    v_pk_mul_f32 v[174:175], v[174:175], v[166:167]
    ds_write_b64 v213, v[186:187] offset:768
    v_pk_fma_f32 v[186:187], v[186:187], v[212:213], v[174:175] op_sel_hi:[1,0,1]
    v_pk_fma_f32 v[186:187], v[176:177], v[168:169], v[186:187]
    s_sub_u32 s82, s82, 1
    s_cbranch_scc1 L_fin_pair
    s_cbranch_vccz L_F_pair
    s_branch L_D_pair
L_T2_pair:
    s_setprio 1
    v_add_u32 v208, v231, v237
    ds_read_b32 v189, v208 offset:0
    ds_read_b32 v191, v208 offset:128
    ds_read_b32 v193, v208 offset:256
    ds_read_b32 v195, v208 offset:384
    s_and_b32 s98, s94, 0xffff0000
    s_and_b32 s99, s95, 0xffff0000
    v_cndmask_b32_e64 v212, 1.0, 0, s[94:95]
    v_mov_b32 v213, v240
    v_cndmask_b32_e64 v8, v196, 0, s[98:99]
    v_cndmask_b32_e64 v9, 0, v196, s[98:99]
    v_lshl_add_u32 v240, v231, 1, v238
    v_mov_b32 v239, v231
    ds_read_b128 v[220:223], v225
    ds_read_b32 v224, v226
    s_waitcnt lgkmcnt(2)
    v_mfma_f32_32x32x8_bf16 v[116:131], v[8:9], v[188:189], v[116:131]
    ds_read_b128 v[228:231], v227
    v_add_u32 v225, 64, v225
    v_add_u32 v226, 64, v226
    v_add_u32 v227, 16, v227
    s_cmp_gt_u32 s82, 2
    s_cselect_b32 s10, 20480000, 0
    s_cmp_gt_u32 s82, 1
    s_cselect_b32 s6, 1283120, 0
    s_nop 5
    v_mfma_f32_32x32x16_bf16 v[132:147], v[96:99], v[36:39], 0
    v_exp_f32 v148, v116
    v_exp_f32 v149, v117
    v_exp_f32 v150, v118
    v_mfma_f32_32x32x16_bf16 v[132:147], v[100:103], v[40:43], v[132:147]
    v_exp_f32 v151, v119
    v_exp_f32 v152, v120
    v_exp_f32 v153, v121
    v_mfma_f32_32x32x16_bf16 v[132:147], v[104:107], v[44:47], v[132:147]
    v_exp_f32 v154, v122
    v_exp_f32 v155, v123
    v_exp_f32 v156, v124
    v_mfma_f32_32x32x16_bf16 v[132:147], v[108:111], v[48:51], v[132:147]
    v_exp_f32 v157, v125
    v_exp_f32 v158, v126
    v_exp_f32 v159, v127
    v_mfma_f32_32x32x16_bf16 v[132:147], v[112:115], v[52:55], v[132:147]
    v_exp_f32 v160, v128
    v_exp_f32 v161, v129
    v_exp_f32 v162, v130
    v_exp_f32 v163, v131
    v_pk_fma_f32 v[148:149], v[148:149], s[40:41], s[40:41]
    v_pk_fma_f32 v[150:151], v[150:151], s[40:41], s[40:41]
    v_pk_fma_f32 v[152:153], v[152:153], s[40:41], s[40:41]
    v_pk_fma_f32 v[154:155], v[154:155], s[40:41], s[40:41]
    v_pk_fma_f32 v[156:157], v[156:157], s[40:41], s[40:41]
    v_pk_fma_f32 v[158:159], v[158:159], s[40:41], s[40:41]
    v_pk_fma_f32 v[160:161], v[160:161], s[40:41], s[40:41]
    v_pk_fma_f32 v[162:163], v[162:163], s[40:41], s[40:41]
    v_pk_mul_f32 v[164:165], v[148:149], v[150:151]
    v_pk_mul_f32 v[166:167], v[152:153], v[154:155]
    v_pk_mul_f32 v[168:169], v[156:157], v[158:159]
    v_pk_mul_f32 v[170:171], v[160:161], v[162:163]
    v_pk_mul_f32 v[172:173], v[116:117], v[150:151]
    v_pk_mul_f32 v[174:175], v[120:121], v[154:155]
    v_pk_mul_f32 v[176:177], v[124:125], v[158:159]
    v_pk_mul_f32 v[178:179], v[128:129], v[162:163]
    v_pk_fma_f32 v[172:173], v[118:119], v[148:149], v[172:173]
    v_pk_fma_f32 v[174:175], v[122:123], v[152:153], v[174:175]
    v_pk_fma_f32 v[176:177], v[126:127], v[156:157], v[176:177]
    v_pk_fma_f32 v[178:179], v[130:131], v[160:161], v[178:179]
    v_pk_mul_f32 v[172:173], v[172:173], v[166:167]
    v_pk_mul_f32 v[176:177], v[176:177], v[170:171]
    v_pk_fma_f32 v[172:173], v[174:175], v[164:165], v[172:173]
    v_pk_fma_f32 v[176:177], v[178:179], v[168:169], v[176:177]
    v_pk_mul_f32 v[164:165], v[164:165], v[166:167]
    v_pk_mul_f32 v[168:169], v[168:169], v[170:171]
    v_mfma_f32_32x32x8_bf16 v[132:147], v[8:9], v[190:191], v[132:147]
    v_rcp_f32 v164, v164
    v_rcp_f32 v165, v165
    v_rcp_f32 v168, v168
    v_rcp_f32 v169, v169
    v_pk_fma_f32 v[180:181], v[172:173], v[164:165], v[180:181]
    v_pk_mul_f32 v[176:177], v[176:177], v[168:169]
    ds_write_b64 v213, v[180:181] offset:0
    v_pk_fma_f32 v[180:181], v[180:181], v[212:213], v[176:177] op_sel_hi:[1,0,1]
    s_waitcnt lgkmcnt(0)
    v_cmp_ne_u32 vcc, v231, v239
    v_add_u32 v220, v220, v232
    v_add_u32 v221, v221, v232
    v_add_u32 v222, v222, v232
    v_mfma_f32_32x32x16_bf16 v[116:131], v[96:99], v[56:59], 0
    v_exp_f32 v148, v132
    v_exp_f32 v149, v133
    v_exp_f32 v150, v134
    v_mfma_f32_32x32x16_bf16 v[116:131], v[100:103], v[60:63], v[116:131]
    v_exp_f32 v151, v135
    v_exp_f32 v152, v136
    v_exp_f32 v153, v137
    v_mfma_f32_32x32x16_bf16 v[116:131], v[104:107], v[64:67], v[116:131]
    v_exp_f32 v154, v138
    v_exp_f32 v155, v139
    v_exp_f32 v156, v140
    v_mfma_f32_32x32x16_bf16 v[116:131], v[108:111], v[68:71], v[116:131]
    v_exp_f32 v157, v141
    v_exp_f32 v158, v142
    v_exp_f32 v159, v143
    v_mfma_f32_32x32x16_bf16 v[116:131], v[112:115], v[72:75], v[116:131]
    v_exp_f32 v160, v144
    v_exp_f32 v161, v145
    v_exp_f32 v162, v146
    v_exp_f32 v163, v147
    v_pk_fma_f32 v[148:149], v[148:149], s[40:41], s[40:41]
    v_pk_fma_f32 v[150:151], v[150:151], s[40:41], s[40:41]
    v_pk_fma_f32 v[152:153], v[152:153], s[40:41], s[40:41]
    v_pk_fma_f32 v[154:155], v[154:155], s[40:41], s[40:41]
    v_pk_fma_f32 v[156:157], v[156:157], s[40:41], s[40:41]
    v_pk_fma_f32 v[158:159], v[158:159], s[40:41], s[40:41]
    v_pk_fma_f32 v[160:161], v[160:161], s[40:41], s[40:41]
    v_pk_fma_f32 v[162:163], v[162:163], s[40:41], s[40:41]
    v_pk_mul_f32 v[164:165], v[148:149], v[150:151]
    v_pk_mul_f32 v[166:167], v[152:153], v[154:155]
    v_pk_mul_f32 v[168:169], v[156:157], v[158:159]
    v_pk_mul_f32 v[170:171], v[160:161], v[162:163]
    v_pk_mul_f32 v[172:173], v[132:133], v[150:151]
    v_pk_mul_f32 v[174:175], v[136:137], v[154:155]
    v_pk_mul_f32 v[176:177], v[140:141], v[158:159]
    v_pk_mul_f32 v[178:179], v[144:145], v[162:163]
    v_pk_fma_f32 v[172:173], v[134:135], v[148:149], v[172:173]
    v_pk_fma_f32 v[174:175], v[138:139], v[152:153], v[174:175]
    v_pk_fma_f32 v[176:177], v[142:143], v[156:157], v[176:177]
    v_pk_fma_f32 v[178:179], v[146:147], v[160:161], v[178:179]
    v_pk_mul_f32 v[172:173], v[172:173], v[166:167]
    v_pk_mul_f32 v[176:177], v[176:177], v[170:171]
    v_pk_fma_f32 v[172:173], v[174:175], v[164:165], v[172:173]
    v_pk_fma_f32 v[176:177], v[178:179], v[168:169], v[176:177]
    v_pk_mul_f32 v[164:165], v[164:165], v[166:167]
    v_pk_mul_f32 v[168:169], v[168:169], v[170:171]
    v_mfma_f32_32x32x8_bf16 v[116:131], v[8:9], v[192:193], v[116:131]
    v_rcp_f32 v164, v164
    v_rcp_f32 v165, v165
    v_rcp_f32 v168, v168
    v_rcp_f32 v169, v169
    v_pk_fma_f32 v[182:183], v[172:173], v[164:165], v[182:183]
    v_pk_mul_f32 v[176:177], v[176:177], v[168:169]
    ds_write_b64 v213, v[182:183] offset:256
    v_pk_fma_f32 v[182:183], v[182:183], v[212:213], v[176:177] op_sel_hi:[1,0,1]
    v_add_u32 v223, v223, v232
    v_add_u32 v224, v224, v233
    v_mfma_f32_32x32x16_bf16 v[132:147], v[96:99], v[76:79], 0
    s_nop 0
    v_exp_f32 v148, v116
    v_exp_f32 v149, v117
    v_exp_f32 v150, v118
    v_mfma_f32_32x32x16_bf16 v[132:147], v[100:103], v[80:83], v[132:147]
    v_exp_f32 v151, v119
    v_exp_f32 v152, v120
    v_exp_f32 v153, v121
    v_mfma_f32_32x32x16_bf16 v[132:147], v[104:107], v[84:87], v[132:147]
    v_exp_f32 v154, v122
    v_exp_f32 v155, v123
    v_exp_f32 v156, v124
    v_mfma_f32_32x32x16_bf16 v[132:147], v[108:111], v[88:91], v[132:147]
    v_exp_f32 v157, v125
    v_exp_f32 v158, v126
    v_exp_f32 v159, v127
    v_mfma_f32_32x32x16_bf16 v[132:147], v[112:115], v[92:95], v[132:147]
    v_exp_f32 v160, v128
    v_exp_f32 v161, v129
    v_exp_f32 v162, v130
    v_exp_f32 v163, v131
    v_pk_fma_f32 v[148:149], v[148:149], s[40:41], s[40:41]
    s_waitcnt vmcnt(1)
    ds_read_b128 v[96:99], v234
    v_pk_fma_f32 v[150:151], v[150:151], s[40:41], s[40:41]
    v_pk_fma_f32 v[152:153], v[152:153], s[40:41], s[40:41]
    v_pk_fma_f32 v[154:155], v[154:155], s[40:41], s[40:41]
    v_pk_fma_f32 v[156:157], v[156:157], s[40:41], s[40:41]
    v_pk_fma_f32 v[158:159], v[158:159], s[40:41], s[40:41]
    ds_read_b128 v[100:103], v234 offset:32
    v_pk_fma_f32 v[160:161], v[160:161], s[40:41], s[40:41]
    v_pk_fma_f32 v[162:163], v[162:163], s[40:41], s[40:41]
    v_pk_mul_f32 v[164:165], v[148:149], v[150:151]
    v_pk_mul_f32 v[166:167], v[152:153], v[154:155]
    v_pk_mul_f32 v[168:169], v[156:157], v[158:159]
    ds_read_b128 v[104:107], v235 offset:64
    v_pk_mul_f32 v[170:171], v[160:161], v[162:163]
    v_pk_mul_f32 v[172:173], v[116:117], v[150:151]
    v_pk_mul_f32 v[174:175], v[120:121], v[154:155]
    v_pk_mul_f32 v[176:177], v[124:125], v[158:159]
    v_pk_mul_f32 v[178:179], v[128:129], v[162:163]
    ds_read_b128 v[108:111], v235 offset:96
    v_pk_fma_f32 v[172:173], v[118:119], v[148:149], v[172:173]
    v_pk_fma_f32 v[174:175], v[122:123], v[152:153], v[174:175]
    v_pk_fma_f32 v[176:177], v[126:127], v[156:157], v[176:177]
    v_pk_fma_f32 v[178:179], v[130:131], v[160:161], v[178:179]
    v_pk_mul_f32 v[172:173], v[172:173], v[166:167]
    ds_read_b128 v[112:115], v236
    v_pk_mul_f32 v[176:177], v[176:177], v[170:171]
    v_pk_fma_f32 v[172:173], v[174:175], v[164:165], v[172:173]
    v_pk_fma_f32 v[176:177], v[178:179], v[168:169], v[176:177]
    v_pk_mul_f32 v[164:165], v[164:165], v[166:167]
    v_pk_mul_f32 v[168:169], v[168:169], v[170:171]
    v_mfma_f32_32x32x8_bf16 v[132:147], v[8:9], v[194:195], v[132:147]
    v_rcp_f32 v164, v164
    v_rcp_f32 v165, v165
    v_rcp_f32 v168, v168
    v_rcp_f32 v169, v169
    v_pk_fma_f32 v[184:185], v[172:173], v[164:165], v[184:185]
    v_pk_mul_f32 v[176:177], v[176:177], v[168:169]
    ds_write_b64 v213, v[184:185] offset:512
    v_pk_fma_f32 v[184:185], v[184:185], v[212:213], v[176:177] op_sel_hi:[1,0,1]
    s_setprio 0
    s_waitcnt lgkmcnt(0)
    buffer_load_dwordx4 v220, s[4:7], s83 offen lds
    buffer_load_dwordx4 v221, s[4:7], s84 offen offset:1040 lds
    buffer_load_dwordx4 v222, s[4:7], s85 offen offset:2080 lds
    v_mfma_f32_32x32x16_bf16 v[116:131], v[96:99], v[16:19], 0
    v_exp_f32 v148, v132
    v_exp_f32 v149, v133
    v_exp_f32 v150, v134
    v_mfma_f32_32x32x16_bf16 v[116:131], v[100:103], v[20:23], v[116:131]
    v_exp_f32 v151, v135
    v_exp_f32 v152, v136
    v_exp_f32 v153, v137
    v_mfma_f32_32x32x16_bf16 v[116:131], v[104:107], v[24:27], v[116:131]
    v_exp_f32 v154, v138
    v_exp_f32 v155, v139
    v_exp_f32 v156, v140
    v_mfma_f32_32x32x16_bf16 v[116:131], v[108:111], v[28:31], v[116:131]
    v_exp_f32 v157, v141
    v_exp_f32 v158, v142
    v_exp_f32 v159, v143
    v_mfma_f32_32x32x16_bf16 v[116:131], v[112:115], v[32:35], v[116:131]
    v_exp_f32 v160, v144
    v_exp_f32 v161, v145
    v_exp_f32 v162, v146
    v_exp_f32 v163, v147
    v_pk_fma_f32 v[148:149], v[148:149], s[40:41], s[40:41]
    buffer_load_dwordx4 v223, s[4:7], 0 offen offset:3120 lds
    v_pk_fma_f32 v[150:151], v[150:151], s[40:41], s[40:41]
    v_pk_fma_f32 v[152:153], v[152:153], s[40:41], s[40:41]
    v_pk_fma_f32 v[154:155], v[154:155], s[40:41], s[40:41]
    v_pk_fma_f32 v[156:157], v[156:157], s[40:41], s[40:41]
    v_pk_fma_f32 v[158:159], v[158:159], s[40:41], s[40:41]
    v_pk_fma_f32 v[160:161], v[160:161], s[40:41], s[40:41]
    v_pk_fma_f32 v[162:163], v[162:163], s[40:41], s[40:41]
    v_pk_mul_f32 v[164:165], v[148:149], v[150:151]
    v_pk_mul_f32 v[166:167], v[152:153], v[154:155]
    v_pk_mul_f32 v[168:169], v[156:157], v[158:159]
    v_pk_mul_f32 v[170:171], v[160:161], v[162:163]
    v_pk_mul_f32 v[172:173], v[132:133], v[150:151]
    s_mov_b32 m0, s88
    s_xor_b32 s88, s88, 1024
    buffer_load_dwordx4 v224, s[8:11], 0 offen nt lds
    s_mov_b32 m0, s86
    v_pk_mul_f32 v[174:175], v[136:137], v[154:155]
    v_pk_mul_f32 v[176:177], v[140:141], v[158:159]
    v_pk_mul_f32 v[178:179], v[144:145], v[162:163]
    v_pk_fma_f32 v[172:173], v[134:135], v[148:149], v[172:173]
    v_pk_fma_f32 v[174:175], v[138:139], v[152:153], v[174:175]
    v_pk_fma_f32 v[176:177], v[142:143], v[156:157], v[176:177]
    v_pk_fma_f32 v[178:179], v[146:147], v[160:161], v[178:179]
    v_pk_mul_f32 v[172:173], v[172:173], v[166:167]
    v_pk_mul_f32 v[176:177], v[176:177], v[170:171]
    v_pk_fma_f32 v[172:173], v[174:175], v[164:165], v[172:173]
    v_pk_fma_f32 v[176:177], v[178:179], v[168:169], v[176:177]
    v_pk_mul_f32 v[164:165], v[164:165], v[166:167]
    v_pk_mul_f32 v[168:169], v[168:169], v[170:171]
    v_rcp_f32 v164, v164
    v_xor_b32 v236, 1024, v236
    v_mov_b32 v188, v189
    v_rcp_f32 v165, v165
    v_mov_b32 v190, v191
    v_mov_b32 v192, v193
    v_rcp_f32 v168, v168
    v_mov_b32 v194, v195
    v_rcp_f32 v169, v169
    v_pk_fma_f32 v[186:187], v[172:173], v[164:165], v[186:187]
    v_pk_mul_f32 v[176:177], v[176:177], v[168:169]
    ds_write_b64 v213, v[186:187] offset:768
    v_pk_fma_f32 v[186:187], v[186:187], v[212:213], v[176:177] op_sel_hi:[1,0,1]
    s_sub_u32 s82, s82, 1
    s_cbranch_scc1 L_fin_pair
    s_cbranch_vccz L_F_pair
    s_branch L_D_pair
L_T3_pair:
    s_setprio 1
    v_add_u32 v208, v231, v237
    ds_read_b32 v189, v208 offset:0
    ds_read_b32 v191, v208 offset:128
    ds_read_b32 v193, v208 offset:256
    ds_read_b32 v195, v208 offset:384
    s_and_b32 s98, s96, 0xff000000
    s_and_b32 s99, s97, 0xff000000
    v_cndmask_b32_e64 v212, 1.0, 0, s[96:97]
    v_mov_b32 v213, v240
    v_cndmask_b32_e64 v8, v196, 0, s[98:99]
    v_cndmask_b32_e64 v9, 0, v196, s[98:99]
    v_lshl_add_u32 v240, v231, 1, v238
    v_mov_b32 v239, v231
    ds_read_b128 v[220:223], v225
    ds_read_b32 v224, v226
    s_waitcnt lgkmcnt(2)
    v_mfma_f32_32x32x8_bf16 v[116:131], v[8:9], v[188:189], v[116:131]
    ds_read_b128 v[228:231], v227
    v_add_u32 v225, 64, v225
    v_add_u32 v226, 64, v226
    v_add_u32 v227, 16, v227
    s_cmp_gt_u32 s82, 2
    s_cselect_b32 s10, 20480000, 0
    s_cmp_gt_u32 s82, 1
    s_cselect_b32 s6, 1283120, 0
    s_nop 5
    v_mfma_f32_32x32x16_bf16 v[132:147], v[96:99], v[36:39], 0
    v_exp_f32 v148, v116
    v_exp_f32 v149, v117
    v_exp_f32 v150, v118
    v_mfma_f32_32x32x16_bf16 v[132:147], v[100:103], v[40:43], v[132:147]
    v_exp_f32 v151, v119
    v_exp_f32 v152, v120
    v_exp_f32 v153, v121
    v_mfma_f32_32x32x16_bf16 v[132:147], v[104:107], v[44:47], v[132:147]
    v_exp_f32 v154, v122
    v_exp_f32 v155, v123
    v_exp_f32 v156, v124
    v_mfma_f32_32x32x16_bf16 v[132:147], v[108:111], v[48:51], v[132:147]
    v_exp_f32 v157, v125
    v_exp_f32 v158, v126
    v_exp_f32 v159, v127
    v_mfma_f32_32x32x16_bf16 v[132:147], v[112:115], v[52:55], v[132:147]
    v_exp_f32 v160, v128
    v_exp_f32 v161, v129
    v_exp_f32 v162, v130
    v_exp_f32 v163, v131
    v_pk_fma_f32 v[148:149], v[148:149], s[40:41], s[40:41]
    v_pk_fma_f32 v[150:151], v[150:151], s[40:41], s[40:41]
    v_pk_fma_f32 v[152:153], v[152:153], s[40:41], s[40:41]
    v_pk_fma_f32 v[154:155], v[154:155], s[40:41], s[40:41]
    v_pk_fma_f32 v[156:157], v[156:157], s[40:41], s[40:41]
    v_pk_fma_f32 v[158:159], v[158:159], s[40:41], s[40:41]
    v_pk_fma_f32 v[160:161], v[160:161], s[40:41], s[40:41]
    v_pk_fma_f32 v[162:163], v[162:163], s[40:41], s[40:41]
    v_pk_mul_f32 v[164:165], v[148:149], v[150:151]
    v_pk_mul_f32 v[166:167], v[152:153], v[154:155]
    v_pk_mul_f32 v[168:169], v[156:157], v[158:159]
    v_pk_mul_f32 v[170:171], v[160:161], v[162:163]
    v_pk_mul_f32 v[172:173], v[116:117], v[150:151]
    v_pk_mul_f32 v[174:175], v[120:121], v[154:155]
    v_pk_mul_f32 v[176:177], v[124:125], v[158:159]
    v_pk_mul_f32 v[178:179], v[128:129], v[162:163]
    v_pk_fma_f32 v[172:173], v[118:119], v[148:149], v[172:173]
    v_pk_fma_f32 v[174:175], v[122:123], v[152:153], v[174:175]
    v_pk_fma_f32 v[176:177], v[126:127], v[156:157], v[176:177]
    v_pk_fma_f32 v[178:179], v[130:131], v[160:161], v[178:179]
    v_pk_mul_f32 v[172:173], v[172:173], v[166:167]
    v_pk_fma_f32 v[172:173], v[174:175], v[164:165], v[172:173]
    v_pk_mul_f32 v[164:165], v[164:165], v[166:167]
    v_mfma_f32_32x32x8_bf16 v[132:147], v[8:9], v[190:191], v[132:147]
    v_rcp_f32 v164, v164
    v_rcp_f32 v165, v165
    v_rcp_f32 v168, v168
    v_rcp_f32 v169, v169
    v_rcp_f32 v170, v170
    v_rcp_f32 v171, v171
    v_pk_fma_f32 v[180:181], v[172:173], v[164:165], v[180:181]
    v_pk_fma_f32 v[180:181], v[176:177], v[168:169], v[180:181]
    v_pk_mul_f32 v[178:179], v[178:179], v[170:171]
    ds_write_b64 v213, v[180:181] offset:0
    v_pk_fma_f32 v[180:181], v[180:181], v[212:213], v[178:179] op_sel_hi:[1,0,1]
    s_waitcnt lgkmcnt(0)
    v_cmp_ne_u32 vcc, v231, v239
    v_add_u32 v220, v220, v232
    v_add_u32 v221, v221, v232
    v_add_u32 v222, v222, v232
    v_mfma_f32_32x32x16_bf16 v[116:131], v[96:99], v[56:59], 0
    v_exp_f32 v148, v132
    v_exp_f32 v149, v133
    v_exp_f32 v150, v134
    v_mfma_f32_32x32x16_bf16 v[116:131], v[100:103], v[60:63], v[116:131]
    v_exp_f32 v151, v135
    v_exp_f32 v152, v136
    v_exp_f32 v153, v137
    v_mfma_f32_32x32x16_bf16 v[116:131], v[104:107], v[64:67], v[116:131]
    v_exp_f32 v154, v138
    v_exp_f32 v155, v139
    v_exp_f32 v156, v140
    v_mfma_f32_32x32x16_bf16 v[116:131], v[108:111], v[68:71], v[116:131]
    v_exp_f32 v157, v141
    v_exp_f32 v158, v142
    v_exp_f32 v159, v143
    v_mfma_f32_32x32x16_bf16 v[116:131], v[112:115], v[72:75], v[116:131]
    v_exp_f32 v160, v144
    v_exp_f32 v161, v145
    v_exp_f32 v162, v146
    v_exp_f32 v163, v147
    v_pk_fma_f32 v[148:149], v[148:149], s[40:41], s[40:41]
    v_pk_fma_f32 v[150:151], v[150:151], s[40:41], s[40:41]
    v_pk_fma_f32 v[152:153], v[152:153], s[40:41], s[40:41]
    v_pk_fma_f32 v[154:155], v[154:155], s[40:41], s[40:41]
    v_pk_fma_f32 v[156:157], v[156:157], s[40:41], s[40:41]
    v_pk_fma_f32 v[158:159], v[158:159], s[40:41], s[40:41]
    v_pk_fma_f32 v[160:161], v[160:161], s[40:41], s[40:41]
    v_pk_fma_f32 v[162:163], v[162:163], s[40:41], s[40:41]
    v_pk_mul_f32 v[164:165], v[148:149], v[150:151]
    v_pk_mul_f32 v[166:167], v[152:153], v[154:155]
    v_pk_mul_f32 v[168:169], v[156:157], v[158:159]
    v_pk_mul_f32 v[170:171], v[160:161], v[162:163]
    v_pk_mul_f32 v[172:173], v[132:133], v[150:151]
    v_pk_mul_f32 v[174:175], v[136:137], v[154:155]
    v_pk_mul_f32 v[176:177], v[140:141], v[158:159]
    v_pk_mul_f32 v[178:179], v[144:145], v[162:163]
    v_pk_fma_f32 v[172:173], v[134:135], v[148:149], v[172:173]
    v_pk_fma_f32 v[174:175], v[138:139], v[152:153], v[174:175]
    v_pk_fma_f32 v[176:177], v[142:143], v[156:157], v[176:177]
    v_pk_fma_f32 v[178:179], v[146:147], v[160:161], v[178:179]
    v_pk_mul_f32 v[172:173], v[172:173], v[166:167]
    v_pk_fma_f32 v[172:173], v[174:175], v[164:165], v[172:173]
    v_pk_mul_f32 v[164:165], v[164:165], v[166:167]
    v_mfma_f32_32x32x8_bf16 v[116:131], v[8:9], v[192:193], v[116:131]
    v_rcp_f32 v164, v164
    v_rcp_f32 v165, v165
    v_rcp_f32 v168, v168
    v_rcp_f32 v169, v169
    v_rcp_f32 v170, v170
    v_rcp_f32 v171, v171
    v_pk_fma_f32 v[182:183], v[172:173], v[164:165], v[182:183]
    v_pk_fma_f32 v[182:183], v[176:177], v[168:169], v[182:183]
    v_pk_mul_f32 v[178:179], v[178:179], v[170:171]
    ds_write_b64 v213, v[182:183] offset:256
    v_pk_fma_f32 v[182:183], v[182:183], v[212:213], v[178:179] op_sel_hi:[1,0,1]
    v_add_u32 v223, v223, v232
    v_add_u32 v224, v224, v233
    v_mfma_f32_32x32x16_bf16 v[132:147], v[96:99], v[76:79], 0
    v_exp_f32 v148, v116
    v_exp_f32 v149, v117
    v_exp_f32 v150, v118
    v_mfma_f32_32x32x16_bf16 v[132:147], v[100:103], v[80:83], v[132:147]
    v_exp_f32 v151, v119
    v_exp_f32 v152, v120
    v_exp_f32 v153, v121
    v_mfma_f32_32x32x16_bf16 v[132:147], v[104:107], v[84:87], v[132:147]
    v_exp_f32 v154, v122
    v_exp_f32 v155, v123
    v_exp_f32 v156, v124
    v_mfma_f32_32x32x16_bf16 v[132:147], v[108:111], v[88:91], v[132:147]
    v_exp_f32 v157, v125
    v_exp_f32 v158, v126
    v_exp_f32 v159, v127
    v_mfma_f32_32x32x16_bf16 v[132:147], v[112:115], v[92:95], v[132:147]
    v_exp_f32 v160, v128
    v_exp_f32 v161, v129
    v_exp_f32 v162, v130
    v_exp_f32 v163, v131
    v_pk_fma_f32 v[148:149], v[148:149], s[40:41], s[40:41]
    s_waitcnt vmcnt(1)
    ds_read_b128 v[96:99], v234
    v_pk_fma_f32 v[150:151], v[150:151], s[40:41], s[40:41]
    v_pk_fma_f32 v[152:153], v[152:153], s[40:41], s[40:41]
    v_pk_fma_f32 v[154:155], v[154:155], s[40:41], s[40:41]
    v_pk_fma_f32 v[156:157], v[156:157], s[40:41], s[40:41]
    ds_read_b128 v[100:103], v234 offset:32
    v_pk_fma_f32 v[158:159], v[158:159], s[40:41], s[40:41]
    v_pk_fma_f32 v[160:161], v[160:161], s[40:41], s[40:41]
    v_pk_fma_f32 v[162:163], v[162:163], s[40:41], s[40:41]
    v_pk_mul_f32 v[164:165], v[148:149], v[150:151]
    ds_read_b128 v[104:107], v235 offset:64
    v_pk_mul_f32 v[166:167], v[152:153], v[154:155]
    v_pk_mul_f32 v[168:169], v[156:157], v[158:159]
    v_pk_mul_f32 v[170:171], v[160:161], v[162:163]
    v_pk_mul_f32 v[172:173], v[116:117], v[150:151]
    v_pk_mul_f32 v[174:175], v[120:121], v[154:155]
    ds_read_b128 v[108:111], v235 offset:96
    v_pk_mul_f32 v[176:177], v[124:125], v[158:159]
    v_pk_mul_f32 v[178:179], v[128:129], v[162:163]
    v_pk_fma_f32 v[172:173], v[118:119], v[148:149], v[172:173]
    v_pk_fma_f32 v[174:175], v[122:123], v[152:153], v[174:175]
    ds_read_b128 v[112:115], v236
    v_pk_fma_f32 v[176:177], v[126:127], v[156:157], v[176:177]
    v_pk_fma_f32 v[178:179], v[130:131], v[160:161], v[178:179]
    v_pk_mul_f32 v[172:173], v[172:173], v[166:167]
    v_pk_fma_f32 v[172:173], v[174:175], v[164:165], v[172:173]
    v_pk_mul_f32 v[164:165], v[164:165], v[166:167]
    v_mfma_f32_32x32x8_bf16 v[132:147], v[8:9], v[194:195], v[132:147]
    v_rcp_f32 v164, v164
    v_rcp_f32 v165, v165
    v_rcp_f32 v168, v168
    v_rcp_f32 v169, v169
    v_rcp_f32 v170, v170
    v_rcp_f32 v171, v171
    v_pk_fma_f32 v[184:185], v[172:173], v[164:165], v[184:185]
    v_pk_fma_f32 v[184:185], v[176:177], v[168:169], v[184:185]
    v_pk_mul_f32 v[178:179], v[178:179], v[170:171]
    ds_write_b64 v213, v[184:185] offset:512
    v_pk_fma_f32 v[184:185], v[184:185], v[212:213], v[178:179] op_sel_hi:[1,0,1]
    s_setprio 0
    s_waitcnt lgkmcnt(0)
    buffer_load_dwordx4 v220, s[4:7], s83 offen lds
    buffer_load_dwordx4 v221, s[4:7], s84 offen offset:1040 lds
    buffer_load_dwordx4 v222, s[4:7], s85 offen offset:2080 lds
    v_mfma_f32_32x32x16_bf16 v[116:131], v[96:99], v[16:19], 0
    v_exp_f32 v148, v132
    v_exp_f32 v149, v133
    v_exp_f32 v150, v134
    v_mfma_f32_32x32x16_bf16 v[116:131], v[100:103], v[20:23], v[116:131]
    v_exp_f32 v151, v135
    v_exp_f32 v152, v136
    v_exp_f32 v153, v137
    v_mfma_f32_32x32x16_bf16 v[116:131], v[104:107], v[24:27], v[116:131]
    v_exp_f32 v154, v138
    v_exp_f32 v155, v139
    v_exp_f32 v156, v140
    v_mfma_f32_32x32x16_bf16 v[116:131], v[108:111], v[28:31], v[116:131]
    v_exp_f32 v157, v141
    v_exp_f32 v158, v142
    v_exp_f32 v159, v143
    v_mfma_f32_32x32x16_bf16 v[116:131], v[112:115], v[32:35], v[116:131]
    v_exp_f32 v160, v144
    v_exp_f32 v161, v145
    v_exp_f32 v162, v146
    v_exp_f32 v163, v147
    v_pk_fma_f32 v[148:149], v[148:149], s[40:41], s[40:41]
    buffer_load_dwordx4 v223, s[4:7], 0 offen offset:3120 lds
    v_pk_fma_f32 v[150:151], v[150:151], s[40:41], s[40:41]
    v_pk_fma_f32 v[152:153], v[152:153], s[40:41], s[40:41]
    v_pk_fma_f32 v[154:155], v[154:155], s[40:41], s[40:41]
    v_pk_fma_f32 v[156:157], v[156:157], s[40:41], s[40:41]
    v_pk_fma_f32 v[158:159], v[158:159], s[40:41], s[40:41]
    v_pk_fma_f32 v[160:161], v[160:161], s[40:41], s[40:41]
    v_pk_fma_f32 v[162:163], v[162:163], s[40:41], s[40:41]
    v_pk_mul_f32 v[164:165], v[148:149], v[150:151]
    v_pk_mul_f32 v[166:167], v[152:153], v[154:155]
    v_pk_mul_f32 v[168:169], v[156:157], v[158:159]
    v_pk_mul_f32 v[170:171], v[160:161], v[162:163]
    s_mov_b32 m0, s88
    s_xor_b32 s88, s88, 1024
    buffer_load_dwordx4 v224, s[8:11], 0 offen nt lds
    s_mov_b32 m0, s86
    v_pk_mul_f32 v[172:173], v[132:133], v[150:151]
    v_pk_mul_f32 v[174:175], v[136:137], v[154:155]
    v_pk_mul_f32 v[176:177], v[140:141], v[158:159]
    v_pk_mul_f32 v[178:179], v[144:145], v[162:163]
    v_pk_fma_f32 v[172:173], v[134:135], v[148:149], v[172:173]
    v_pk_fma_f32 v[174:175], v[138:139], v[152:153], v[174:175]
    v_pk_fma_f32 v[176:177], v[142:143], v[156:157], v[176:177]
    v_pk_fma_f32 v[178:179], v[146:147], v[160:161], v[178:179]
    v_pk_mul_f32 v[172:173], v[172:173], v[166:167]
    v_pk_fma_f32 v[172:173], v[174:175], v[164:165], v[172:173]
    v_pk_mul_f32 v[164:165], v[164:165], v[166:167]
    v_rcp_f32 v164, v164
    v_xor_b32 v236, 1024, v236
    v_rcp_f32 v165, v165
    v_mov_b32 v188, v189
    v_rcp_f32 v168, v168
    v_mov_b32 v190, v191
    v_rcp_f32 v169, v169
    v_mov_b32 v192, v193
    v_rcp_f32 v170, v170
    v_mov_b32 v194, v195
    v_rcp_f32 v171, v171
    v_pk_fma_f32 v[186:187], v[172:173], v[164:165], v[186:187]
    v_pk_fma_f32 v[186:187], v[176:177], v[168:169], v[186:187]
    v_pk_mul_f32 v[178:179], v[178:179], v[170:171]
    ds_write_b64 v213, v[186:187] offset:768
    v_pk_fma_f32 v[186:187], v[186:187], v[212:213], v[178:179] op_sel_hi:[1,0,1]
    s_sub_u32 s82, s82, 1
    s_cbranch_scc1 L_fin_pair
    s_cbranch_vccz L_F_pair
    s_branch L_D_pair
L_S_pair:
    s_setprio 1
    v_add_u32 v208, v228, v237
    v_add_u32 v209, v229, v237
    v_add_u32 v210, v230, v237
    v_add_u32 v211, v231, v237
    ds_read_b32 v204, v208
    ds_read_b32 v205, v209
    ds_read_b32 v206, v210
    ds_read_b32 v207, v211
    ds_read_b32 v188, v211 offset:0
    ds_read_b32 v190, v211 offset:128
    ds_read_b32 v192, v211 offset:256
    ds_read_b32 v194, v211 offset:384
    v_cmp_eq_u32 s[90:91], v228, v239
    v_cmp_eq_u32 s[92:93], v229, v228
    v_cmp_eq_u32 s[94:95], v230, v229
    v_cmp_eq_u32 s[96:97], v231, v230
    v_mov_b32 v213, v240
    v_lshl_add_u32 v215, v228, 1, v238
    v_lshl_add_u32 v217, v229, 1, v238
    v_lshl_add_u32 v219, v230, 1, v238
    v_lshl_add_u32 v240, v231, 1, v238
    v_mov_b32 v239, v231
    v_cndmask_b32_e64 v212, 0, 1.0, s[90:91]
    v_cndmask_b32_e64 v214, 0, 1.0, s[92:93]
    v_cndmask_b32_e64 v216, 0, 1.0, s[94:95]
    v_cndmask_b32_e64 v218, 0, 1.0, s[96:97]
    s_waitcnt lgkmcnt(0)
    v_mfma_f32_32x32x16_bf16 v[116:131], v[200:203], v[204:207], v[116:131]
    ds_read_b128 v[220:223], v225
    ds_read_b32 v224, v226
    ds_read_b128 v[228:231], v227
    v_add_u32 v225, 64, v225
    v_add_u32 v226, 64, v226
    v_add_u32 v227, 16, v227
    s_cmp_gt_u32 s82, 2
    s_cselect_b32 s10, 20480000, 0
    s_cmp_gt_u32 s82, 1
    s_cselect_b32 s6, 1283120, 0
    s_nop 3
    ds_read_b32 v204, v208 offset:128
    ds_read_b32 v205, v209 offset:128
    ds_read_b32 v206, v210 offset:128
    ds_read_b32 v207, v211 offset:128
    v_mfma_f32_32x32x16_bf16 v[132:147], v[96:99], v[36:39], 0
    v_exp_f32 v148, v116
    v_exp_f32 v149, v117
    v_exp_f32 v150, v118
    v_mfma_f32_32x32x16_bf16 v[132:147], v[100:103], v[40:43], v[132:147]
    v_exp_f32 v151, v119
    v_exp_f32 v152, v120
    v_exp_f32 v153, v121
    v_mfma_f32_32x32x16_bf16 v[132:147], v[104:107], v[44:47], v[132:147]
    v_exp_f32 v154, v122
    v_exp_f32 v155, v123
    v_exp_f32 v156, v124
    v_mfma_f32_32x32x16_bf16 v[132:147], v[108:111], v[48:51], v[132:147]
    v_exp_f32 v157, v125
    v_exp_f32 v158, v126
    v_exp_f32 v159, v127
    v_mfma_f32_32x32x16_bf16 v[132:147], v[112:115], v[52:55], v[132:147]
    v_exp_f32 v160, v128
    v_exp_f32 v161, v129
    v_exp_f32 v162, v130
    v_exp_f32 v163, v131
    v_pk_fma_f32 v[148:149], v[148:149], s[40:41], s[40:41]
    v_pk_fma_f32 v[150:151], v[150:151], s[40:41], s[40:41]
    v_pk_fma_f32 v[152:153], v[152:153], s[40:41], s[40:41]
    v_pk_fma_f32 v[154:155], v[154:155], s[40:41], s[40:41]
    v_pk_fma_f32 v[156:157], v[156:157], s[40:41], s[40:41]
    v_pk_fma_f32 v[158:159], v[158:159], s[40:41], s[40:41]
    v_pk_fma_f32 v[160:161], v[160:161], s[40:41], s[40:41]
    v_pk_fma_f32 v[162:163], v[162:163], s[40:41], s[40:41]
    v_pk_mul_f32 v[164:165], v[148:149], v[150:151]
    v_pk_mul_f32 v[166:167], v[152:153], v[154:155]
    v_pk_mul_f32 v[168:169], v[156:157], v[158:159]
    v_pk_mul_f32 v[170:171], v[160:161], v[162:163]
    v_pk_mul_f32 v[172:173], v[116:117], v[150:151]
    v_pk_mul_f32 v[174:175], v[120:121], v[154:155]
    v_pk_mul_f32 v[176:177], v[124:125], v[158:159]
    v_pk_mul_f32 v[178:179], v[128:129], v[162:163]
    v_rcp_f32 v164, v164
    s_waitcnt lgkmcnt(0)
    v_mfma_f32_32x32x16_bf16 v[132:147], v[200:203], v[204:207], v[132:147]
    v_rcp_f32 v165, v165
    v_rcp_f32 v166, v166
    v_rcp_f32 v167, v167
    v_rcp_f32 v168, v168
    v_rcp_f32 v169, v169
    v_rcp_f32 v170, v170
    v_rcp_f32 v171, v171
    v_pk_fma_f32 v[172:173], v[118:119], v[148:149], v[172:173]
    v_pk_fma_f32 v[174:175], v[122:123], v[152:153], v[174:175]
    v_pk_fma_f32 v[176:177], v[126:127], v[156:157], v[176:177]
    v_pk_fma_f32 v[178:179], v[130:131], v[160:161], v[178:179]
    v_pk_mul_f32 v[172:173], v[172:173], v[164:165]
    v_pk_mul_f32 v[174:175], v[174:175], v[166:167]
    v_pk_mul_f32 v[176:177], v[176:177], v[168:169]
    v_pk_mul_f32 v[178:179], v[178:179], v[170:171]
    ds_write_b64 v213, v[180:181] offset:0
    v_pk_fma_f32 v[180:181], v[180:181], v[212:213], v[172:173] op_sel_hi:[1,0,1]
    ds_write_b64 v215, v[180:181] offset:0
    v_pk_fma_f32 v[180:181], v[180:181], v[214:215], v[174:175] op_sel_hi:[1,0,1]
    ds_write_b64 v217, v[180:181] offset:0
    v_pk_fma_f32 v[180:181], v[180:181], v[216:217], v[176:177] op_sel_hi:[1,0,1]
    ds_write_b64 v219, v[180:181] offset:0
    v_pk_fma_f32 v[180:181], v[180:181], v[218:219], v[178:179] op_sel_hi:[1,0,1]
    s_waitcnt lgkmcnt(0)
    ds_read_b32 v204, v208 offset:256
    ds_read_b32 v205, v209 offset:256
    ds_read_b32 v206, v210 offset:256
    ds_read_b32 v207, v211 offset:256
    v_mfma_f32_32x32x16_bf16 v[116:131], v[96:99], v[56:59], 0
    v_cmp_ne_u32 vcc, v231, v239
    v_exp_f32 v148, v132
    v_exp_f32 v149, v133
    v_exp_f32 v150, v134
    v_add_u32 v220, v220, v232
    v_mfma_f32_32x32x16_bf16 v[116:131], v[100:103], v[60:63], v[116:131]
    v_exp_f32 v151, v135
    v_exp_f32 v152, v136
    v_add_u32 v221, v221, v232
    v_exp_f32 v153, v137
    v_mfma_f32_32x32x16_bf16 v[116:131], v[104:107], v[64:67], v[116:131]
    v_exp_f32 v154, v138
    v_exp_f32 v155, v139
    v_add_u32 v222, v222, v232
    v_exp_f32 v156, v140
    v_mfma_f32_32x32x16_bf16 v[116:131], v[108:111], v[68:71], v[116:131]
    v_exp_f32 v157, v141
    v_add_u32 v223, v223, v232
    v_exp_f32 v158, v142
    v_exp_f32 v159, v143
    v_mfma_f32_32x32x16_bf16 v[116:131], v[112:115], v[72:75], v[116:131]
    v_add_u32 v224, v224, v233
    v_exp_f32 v160, v144
    v_exp_f32 v161, v145
    v_exp_f32 v162, v146
    v_exp_f32 v163, v147
    v_pk_fma_f32 v[148:149], v[148:149], s[40:41], s[40:41]
    v_pk_fma_f32 v[150:151], v[150:151], s[40:41], s[40:41]
    v_pk_fma_f32 v[152:153], v[152:153], s[40:41], s[40:41]
    v_pk_fma_f32 v[154:155], v[154:155], s[40:41], s[40:41]
    v_pk_fma_f32 v[156:157], v[156:157], s[40:41], s[40:41]
    v_pk_fma_f32 v[158:159], v[158:159], s[40:41], s[40:41]
    v_pk_fma_f32 v[160:161], v[160:161], s[40:41], s[40:41]
    v_pk_fma_f32 v[162:163], v[162:163], s[40:41], s[40:41]
    v_pk_mul_f32 v[164:165], v[148:149], v[150:151]
    v_pk_mul_f32 v[166:167], v[152:153], v[154:155]
    v_pk_mul_f32 v[168:169], v[156:157], v[158:159]
    v_pk_mul_f32 v[170:171], v[160:161], v[162:163]
    v_pk_mul_f32 v[172:173], v[132:133], v[150:151]
    v_pk_mul_f32 v[174:175], v[136:137], v[154:155]
    v_pk_mul_f32 v[176:177], v[140:141], v[158:159]
    v_pk_mul_f32 v[178:179], v[144:145], v[162:163]
    v_rcp_f32 v164, v164
    s_waitcnt lgkmcnt(0)
    v_mfma_f32_32x32x16_bf16 v[116:131], v[200:203], v[204:207], v[116:131]
    v_rcp_f32 v165, v165
    v_rcp_f32 v166, v166
    v_rcp_f32 v167, v167
    v_rcp_f32 v168, v168
    v_rcp_f32 v169, v169
    v_rcp_f32 v170, v170
    v_rcp_f32 v171, v171
    v_pk_fma_f32 v[172:173], v[134:135], v[148:149], v[172:173]
    v_pk_fma_f32 v[174:175], v[138:139], v[152:153], v[174:175]
    v_pk_fma_f32 v[176:177], v[142:143], v[156:157], v[176:177]
    v_pk_fma_f32 v[178:179], v[146:147], v[160:161], v[178:179]
    v_pk_mul_f32 v[172:173], v[172:173], v[164:165]
    v_pk_mul_f32 v[174:175], v[174:175], v[166:167]
    v_pk_mul_f32 v[176:177], v[176:177], v[168:169]
    v_pk_mul_f32 v[178:179], v[178:179], v[170:171]
    ds_write_b64 v213, v[182:183] offset:256
    v_pk_fma_f32 v[182:183], v[182:183], v[212:213], v[172:173] op_sel_hi:[1,0,1]
    ds_write_b64 v215, v[182:183] offset:256
    v_pk_fma_f32 v[182:183], v[182:183], v[214:215], v[174:175] op_sel_hi:[1,0,1]
    ds_write_b64 v217, v[182:183] offset:256
    v_pk_fma_f32 v[182:183], v[182:183], v[216:217], v[176:177] op_sel_hi:[1,0,1]
    ds_write_b64 v219, v[182:183] offset:256
    v_pk_fma_f32 v[182:183], v[182:183], v[218:219], v[178:179] op_sel_hi:[1,0,1]
    ds_read_b32 v204, v208 offset:384
    ds_read_b32 v205, v209 offset:384
    ds_read_b32 v206, v210 offset:384
    ds_read_b32 v207, v211 offset:384
    v_mfma_f32_32x32x16_bf16 v[132:147], v[96:99], v[76:79], 0
    v_exp_f32 v148, v116
    v_exp_f32 v149, v117
    v_exp_f32 v150, v118
    v_mfma_f32_32x32x16_bf16 v[132:147], v[100:103], v[80:83], v[132:147]
    v_exp_f32 v151, v119
    v_exp_f32 v152, v120
    v_exp_f32 v153, v121
    v_mfma_f32_32x32x16_bf16 v[132:147], v[104:107], v[84:87], v[132:147]
    v_exp_f32 v154, v122
    v_exp_f32 v155, v123
    v_exp_f32 v156, v124
    v_mfma_f32_32x32x16_bf16 v[132:147], v[108:111], v[88:91], v[132:147]
    v_exp_f32 v157, v125
    v_exp_f32 v158, v126
    v_exp_f32 v159, v127
    v_mfma_f32_32x32x16_bf16 v[132:147], v[112:115], v[92:95], v[132:147]
    v_exp_f32 v160, v128
    v_exp_f32 v161, v129
    v_exp_f32 v162, v130
    v_exp_f32 v163, v131
    v_pk_fma_f32 v[148:149], v[148:149], s[40:41], s[40:41]
    s_waitcnt vmcnt(1)
    ds_read_b128 v[96:99], v234
    v_pk_fma_f32 v[150:151], v[150:151], s[40:41], s[40:41]
    v_pk_fma_f32 v[152:153], v[152:153], s[40:41], s[40:41]
    v_pk_fma_f32 v[154:155], v[154:155], s[40:41], s[40:41]
    ds_read_b128 v[100:103], v234 offset:32
    v_pk_fma_f32 v[156:157], v[156:157], s[40:41], s[40:41]
    v_pk_fma_f32 v[158:159], v[158:159], s[40:41], s[40:41]
    v_pk_fma_f32 v[160:161], v[160:161], s[40:41], s[40:41]
    ds_read_b128 v[104:107], v235 offset:64
    v_pk_fma_f32 v[162:163], v[162:163], s[40:41], s[40:41]
    v_pk_mul_f32 v[164:165], v[148:149], v[150:151]
    v_pk_mul_f32 v[166:167], v[152:153], v[154:155]
    ds_read_b128 v[108:111], v235 offset:96
    v_pk_mul_f32 v[168:169], v[156:157], v[158:159]
    v_pk_mul_f32 v[170:171], v[160:161], v[162:163]
    v_pk_mul_f32 v[172:173], v[116:117], v[150:151]
    ds_read_b128 v[112:115], v236
    v_pk_mul_f32 v[174:175], v[120:121], v[154:155]
    v_pk_mul_f32 v[176:177], v[124:125], v[158:159]
    v_pk_mul_f32 v[178:179], v[128:129], v[162:163]
    v_rcp_f32 v164, v164
    s_waitcnt lgkmcnt(5)
    v_mfma_f32_32x32x16_bf16 v[132:147], v[200:203], v[204:207], v[132:147]
    v_rcp_f32 v165, v165
    v_rcp_f32 v166, v166
    v_rcp_f32 v167, v167
    v_rcp_f32 v168, v168
    v_rcp_f32 v169, v169
    v_rcp_f32 v170, v170
    v_rcp_f32 v171, v171
    v_pk_fma_f32 v[172:173], v[118:119], v[148:149], v[172:173]
    v_pk_fma_f32 v[174:175], v[122:123], v[152:153], v[174:175]
    v_pk_fma_f32 v[176:177], v[126:127], v[156:157], v[176:177]
    v_pk_fma_f32 v[178:179], v[130:131], v[160:161], v[178:179]
    v_pk_mul_f32 v[172:173], v[172:173], v[164:165]
    v_pk_mul_f32 v[174:175], v[174:175], v[166:167]
    v_pk_mul_f32 v[176:177], v[176:177], v[168:169]
    v_pk_mul_f32 v[178:179], v[178:179], v[170:171]
    ds_write_b64 v213, v[184:185] offset:512
    v_pk_fma_f32 v[184:185], v[184:185], v[212:213], v[172:173] op_sel_hi:[1,0,1]
    ds_write_b64 v215, v[184:185] offset:512
    v_pk_fma_f32 v[184:185], v[184:185], v[214:215], v[174:175] op_sel_hi:[1,0,1]
    ds_write_b64 v217, v[184:185] offset:512
    v_pk_fma_f32 v[184:185], v[184:185], v[216:217], v[176:177] op_sel_hi:[1,0,1]
    ds_write_b64 v219, v[184:185] offset:512
    v_pk_fma_f32 v[184:185], v[184:185], v[218:219], v[178:179] op_sel_hi:[1,0,1]
    s_setprio 0
    s_waitcnt lgkmcnt(0)
    v_mfma_f32_32x32x16_bf16 v[116:131], v[96:99], v[16:19], 0
    buffer_load_dwordx4 v220, s[4:7], s83 offen lds
    v_exp_f32 v148, v132
    v_exp_f32 v149, v133
    v_exp_f32 v150, v134
    v_mfma_f32_32x32x16_bf16 v[116:131], v[100:103], v[20:23], v[116:131]
    v_exp_f32 v151, v135
    v_exp_f32 v152, v136
    buffer_load_dwordx4 v221, s[4:7], s84 offen offset:1040 lds
    v_exp_f32 v153, v137
    v_mfma_f32_32x32x16_bf16 v[116:131], v[104:107], v[24:27], v[116:131]
    v_exp_f32 v154, v138
    v_exp_f32 v155, v139
    v_exp_f32 v156, v140
    v_mfma_f32_32x32x16_bf16 v[116:131], v[108:111], v[28:31], v[116:131]
    v_exp_f32 v157, v141
    buffer_load_dwordx4 v222, s[4:7], s85 offen offset:2080 lds
    v_exp_f32 v158, v142
    v_exp_f32 v159, v143
    v_mfma_f32_32x32x16_bf16 v[116:131], v[112:115], v[32:35], v[116:131]
    v_exp_f32 v160, v144
    v_exp_f32 v161, v145
    v_exp_f32 v162, v146
    v_exp_f32 v163, v147
    v_pk_fma_f32 v[148:149], v[148:149], s[40:41], s[40:41]
    buffer_load_dwordx4 v223, s[4:7], 0 offen offset:3120 lds
    v_pk_fma_f32 v[150:151], v[150:151], s[40:41], s[40:41]
    v_pk_fma_f32 v[152:153], v[152:153], s[40:41], s[40:41]
    v_pk_fma_f32 v[154:155], v[154:155], s[40:41], s[40:41]
    v_pk_fma_f32 v[156:157], v[156:157], s[40:41], s[40:41]
    v_pk_fma_f32 v[158:159], v[158:159], s[40:41], s[40:41]
    v_pk_fma_f32 v[160:161], v[160:161], s[40:41], s[40:41]
    v_pk_fma_f32 v[162:163], v[162:163], s[40:41], s[40:41]
    s_mov_b32 m0, s88
    s_xor_b32 s88, s88, 1024
    buffer_load_dwordx4 v224, s[8:11], 0 offen nt lds
    s_mov_b32 m0, s86
    v_pk_mul_f32 v[164:165], v[148:149], v[150:151]
    v_pk_mul_f32 v[166:167], v[152:153], v[154:155]
    v_pk_mul_f32 v[168:169], v[156:157], v[158:159]
    v_pk_mul_f32 v[170:171], v[160:161], v[162:163]
    v_pk_mul_f32 v[172:173], v[132:133], v[150:151]
    v_pk_mul_f32 v[174:175], v[136:137], v[154:155]
    v_pk_mul_f32 v[176:177], v[140:141], v[158:159]
    v_pk_mul_f32 v[178:179], v[144:145], v[162:163]
    v_rcp_f32 v164, v164
    v_rcp_f32 v165, v165
    v_xor_b32 v236, 1024, v236
    v_rcp_f32 v166, v166
    v_rcp_f32 v167, v167
    v_rcp_f32 v168, v168
    v_rcp_f32 v169, v169
    v_rcp_f32 v170, v170
    v_rcp_f32 v171, v171
    v_pk_fma_f32 v[172:173], v[134:135], v[148:149], v[172:173]
    v_pk_fma_f32 v[174:175], v[138:139], v[152:153], v[174:175]
    v_pk_fma_f32 v[176:177], v[142:143], v[156:157], v[176:177]
    v_pk_fma_f32 v[178:179], v[146:147], v[160:161], v[178:179]
    v_pk_mul_f32 v[172:173], v[172:173], v[164:165]
    v_pk_mul_f32 v[174:175], v[174:175], v[166:167]
    v_pk_mul_f32 v[176:177], v[176:177], v[168:169]
    v_pk_mul_f32 v[178:179], v[178:179], v[170:171]
    ds_write_b64 v213, v[186:187] offset:768
    v_pk_fma_f32 v[186:187], v[186:187], v[212:213], v[172:173] op_sel_hi:[1,0,1]
    ds_write_b64 v215, v[186:187] offset:768
    v_pk_fma_f32 v[186:187], v[186:187], v[214:215], v[174:175] op_sel_hi:[1,0,1]
    ds_write_b64 v217, v[186:187] offset:768
    v_pk_fma_f32 v[186:187], v[186:187], v[216:217], v[176:177] op_sel_hi:[1,0,1]
    ds_write_b64 v219, v[186:187] offset:768
    v_pk_fma_f32 v[186:187], v[186:187], v[218:219], v[178:179] op_sel_hi:[1,0,1]
    s_sub_u32 s82, s82, 1
    s_cbranch_scc1 L_fin_pair
    s_cbranch_vccz L_F_pair
    s_branch L_D_pair
L_fin_pair:
    s_branch L_fin_safe
L_S_safe:
    s_setprio 1
    v_add_u32 v208, v228, v237
    v_add_u32 v209, v229, v237
    v_add_u32 v210, v230, v237
    v_add_u32 v211, v231, v237
    ds_read_b32 v204, v208
    ds_read_b32 v205, v209
    ds_read_b32 v206, v210
    ds_read_b32 v207, v211
    ds_read_b32 v188, v211 offset:0
    ds_read_b32 v190, v211 offset:128
    ds_read_b32 v192, v211 offset:256
    ds_read_b32 v194, v211 offset:384
    v_cmp_eq_u32 s[90:91], v228, v239
    v_cmp_eq_u32 s[92:93], v229, v228
    v_cmp_eq_u32 s[94:95], v230, v229
    v_cmp_eq_u32 s[96:97], v231, v230
    v_mov_b32 v213, v240
    v_lshl_add_u32 v215, v228, 1, v238
    v_lshl_add_u32 v217, v229, 1, v238
    v_lshl_add_u32 v219, v230, 1, v238
    v_lshl_add_u32 v240, v231, 1, v238
    v_mov_b32 v239, v231
    v_cndmask_b32_e64 v212, 0, 1.0, s[90:91]
    v_cndmask_b32_e64 v214, 0, 1.0, s[92:93]
    v_cndmask_b32_e64 v216, 0, 1.0, s[94:95]
    v_cndmask_b32_e64 v218, 0, 1.0, s[96:97]
    s_waitcnt lgkmcnt(0)
    v_mfma_f32_32x32x16_bf16 v[116:131], v[200:203], v[204:207], v[116:131]
    ds_read_b128 v[220:223], v225
    ds_read_b32 v224, v226
    ds_read_b128 v[228:231], v227
    v_add_u32 v225, 64, v225
    v_add_u32 v226, 64, v226
    v_add_u32 v227, 16, v227
    s_cmp_gt_u32 s82, 2
    s_cselect_b32 s10, 20480000, 0
    s_cmp_gt_u32 s82, 1
    s_cselect_b32 s6, 1283120, 0
    s_nop 3
    ds_read_b32 v204, v208 offset:128
    ds_read_b32 v205, v209 offset:128
    ds_read_b32 v206, v210 offset:128
    ds_read_b32 v207, v211 offset:128
    v_mfma_f32_32x32x16_bf16 v[132:147], v[96:99], v[36:39], 0
    v_exp_f32 v148, v116
    v_exp_f32 v149, v117
    v_exp_f32 v150, v118
    v_mfma_f32_32x32x16_bf16 v[132:147], v[100:103], v[40:43], v[132:147]
    v_exp_f32 v151, v119
    v_exp_f32 v152, v120
    v_exp_f32 v153, v121
    v_mfma_f32_32x32x16_bf16 v[132:147], v[104:107], v[44:47], v[132:147]
    v_exp_f32 v154, v122
    v_exp_f32 v155, v123
    v_exp_f32 v156, v124
    v_mfma_f32_32x32x16_bf16 v[132:147], v[108:111], v[48:51], v[132:147]
    v_exp_f32 v157, v125
    v_exp_f32 v158, v126
    v_exp_f32 v159, v127
    v_mfma_f32_32x32x16_bf16 v[132:147], v[112:115], v[52:55], v[132:147]
    v_exp_f32 v160, v128
    v_exp_f32 v161, v129
    v_exp_f32 v162, v130
    v_exp_f32 v163, v131
    v_pk_fma_f32 v[148:149], v[148:149], s[40:41], s[40:41]
    v_pk_fma_f32 v[150:151], v[150:151], s[40:41], s[40:41]
    v_pk_fma_f32 v[152:153], v[152:153], s[40:41], s[40:41]
    v_pk_fma_f32 v[154:155], v[154:155], s[40:41], s[40:41]
    v_pk_fma_f32 v[156:157], v[156:157], s[40:41], s[40:41]
    v_pk_fma_f32 v[158:159], v[158:159], s[40:41], s[40:41]
    v_pk_fma_f32 v[160:161], v[160:161], s[40:41], s[40:41]
    v_pk_fma_f32 v[162:163], v[162:163], s[40:41], s[40:41]
    v_rcp_f32 v148, v148
    s_waitcnt lgkmcnt(0)
    v_mfma_f32_32x32x16_bf16 v[132:147], v[200:203], v[204:207], v[132:147]
    v_rcp_f32 v149, v149
    v_rcp_f32 v150, v150
    v_rcp_f32 v151, v151
    v_rcp_f32 v152, v152
    v_rcp_f32 v153, v153
    v_rcp_f32 v154, v154
    v_rcp_f32 v155, v155
    v_rcp_f32 v156, v156
    v_rcp_f32 v157, v157
    v_rcp_f32 v158, v158
    v_rcp_f32 v159, v159
    v_rcp_f32 v160, v160
    v_rcp_f32 v161, v161
    v_rcp_f32 v162, v162
    v_rcp_f32 v163, v163
    v_pk_mul_f32 v[172:173], v[116:117], v[148:149]
    v_pk_mul_f32 v[174:175], v[120:121], v[152:153]
    v_pk_mul_f32 v[176:177], v[124:125], v[156:157]
    v_pk_mul_f32 v[178:179], v[128:129], v[160:161]
    v_pk_fma_f32 v[172:173], v[118:119], v[150:151], v[172:173]
    v_pk_fma_f32 v[174:175], v[122:123], v[154:155], v[174:175]
    v_pk_fma_f32 v[176:177], v[126:127], v[158:159], v[176:177]
    v_pk_fma_f32 v[178:179], v[130:131], v[162:163], v[178:179]
    ds_write_b64 v213, v[180:181] offset:0
    v_pk_fma_f32 v[180:181], v[180:181], v[212:213], v[172:173] op_sel_hi:[1,0,1]
    ds_write_b64 v215, v[180:181] offset:0
    v_pk_fma_f32 v[180:181], v[180:181], v[214:215], v[174:175] op_sel_hi:[1,0,1]
    ds_write_b64 v217, v[180:181] offset:0
    v_pk_fma_f32 v[180:181], v[180:181], v[216:217], v[176:177] op_sel_hi:[1,0,1]
    ds_write_b64 v219, v[180:181] offset:0
    v_pk_fma_f32 v[180:181], v[180:181], v[218:219], v[178:179] op_sel_hi:[1,0,1]
    s_waitcnt lgkmcnt(0)
    ds_read_b32 v204, v208 offset:256
    ds_read_b32 v205, v209 offset:256
    ds_read_b32 v206, v210 offset:256
    ds_read_b32 v207, v211 offset:256
    v_mfma_f32_32x32x16_bf16 v[116:131], v[96:99], v[56:59], 0
    v_cmp_ne_u32 vcc, v231, v239
    v_exp_f32 v148, v132
    v_exp_f32 v149, v133
    v_exp_f32 v150, v134
    v_add_u32 v220, v220, v232
    v_mfma_f32_32x32x16_bf16 v[116:131], v[100:103], v[60:63], v[116:131]
    v_exp_f32 v151, v135
    v_exp_f32 v152, v136
    v_add_u32 v221, v221, v232
    v_exp_f32 v153, v137
    v_mfma_f32_32x32x16_bf16 v[116:131], v[104:107], v[64:67], v[116:131]
    v_exp_f32 v154, v138
    v_exp_f32 v155, v139
    v_add_u32 v222, v222, v232
    v_exp_f32 v156, v140
    v_mfma_f32_32x32x16_bf16 v[116:131], v[108:111], v[68:71], v[116:131]
    v_exp_f32 v157, v141
    v_add_u32 v223, v223, v232
    v_exp_f32 v158, v142
    v_exp_f32 v159, v143
    v_mfma_f32_32x32x16_bf16 v[116:131], v[112:115], v[72:75], v[116:131]
    v_add_u32 v224, v224, v233
    v_exp_f32 v160, v144
    v_exp_f32 v161, v145
    v_exp_f32 v162, v146
    v_exp_f32 v163, v147
    v_pk_fma_f32 v[148:149], v[148:149], s[40:41], s[40:41]
    v_pk_fma_f32 v[150:151], v[150:151], s[40:41], s[40:41]
    v_pk_fma_f32 v[152:153], v[152:153], s[40:41], s[40:41]
    v_pk_fma_f32 v[154:155], v[154:155], s[40:41], s[40:41]
    v_pk_fma_f32 v[156:157], v[156:157], s[40:41], s[40:41]
    v_pk_fma_f32 v[158:159], v[158:159], s[40:41], s[40:41]
    v_pk_fma_f32 v[160:161], v[160:161], s[40:41], s[40:41]
    v_pk_fma_f32 v[162:163], v[162:163], s[40:41], s[40:41]
    v_rcp_f32 v148, v148
    s_waitcnt lgkmcnt(0)
    v_mfma_f32_32x32x16_bf16 v[116:131], v[200:203], v[204:207], v[116:131]
    v_rcp_f32 v149, v149
    v_rcp_f32 v150, v150
    v_rcp_f32 v151, v151
    v_rcp_f32 v152, v152
    v_rcp_f32 v153, v153
    v_rcp_f32 v154, v154
    v_rcp_f32 v155, v155
    v_rcp_f32 v156, v156
    v_rcp_f32 v157, v157
    v_rcp_f32 v158, v158
    v_rcp_f32 v159, v159
    v_rcp_f32 v160, v160
    v_rcp_f32 v161, v161
    v_rcp_f32 v162, v162
    v_rcp_f32 v163, v163
    v_pk_mul_f32 v[172:173], v[132:133], v[148:149]
    v_pk_mul_f32 v[174:175], v[136:137], v[152:153]
    v_pk_mul_f32 v[176:177], v[140:141], v[156:157]
    v_pk_mul_f32 v[178:179], v[144:145], v[160:161]
    v_pk_fma_f32 v[172:173], v[134:135], v[150:151], v[172:173]
    v_pk_fma_f32 v[174:175], v[138:139], v[154:155], v[174:175]
    v_pk_fma_f32 v[176:177], v[142:143], v[158:159], v[176:177]
    v_pk_fma_f32 v[178:179], v[146:147], v[162:163], v[178:179]
    ds_write_b64 v213, v[182:183] offset:256
    v_pk_fma_f32 v[182:183], v[182:183], v[212:213], v[172:173] op_sel_hi:[1,0,1]
    ds_write_b64 v215, v[182:183] offset:256
    v_pk_fma_f32 v[182:183], v[182:183], v[214:215], v[174:175] op_sel_hi:[1,0,1]
    ds_write_b64 v217, v[182:183] offset:256
    v_pk_fma_f32 v[182:183], v[182:183], v[216:217], v[176:177] op_sel_hi:[1,0,1]
    ds_write_b64 v219, v[182:183] offset:256
    v_pk_fma_f32 v[182:183], v[182:183], v[218:219], v[178:179] op_sel_hi:[1,0,1]
    ds_read_b32 v204, v208 offset:384
    ds_read_b32 v205, v209 offset:384
    ds_read_b32 v206, v210 offset:384
    ds_read_b32 v207, v211 offset:384
    v_mfma_f32_32x32x16_bf16 v[132:147], v[96:99], v[76:79], 0
    v_exp_f32 v148, v116
    v_exp_f32 v149, v117
    v_exp_f32 v150, v118
    v_mfma_f32_32x32x16_bf16 v[132:147], v[100:103], v[80:83], v[132:147]
    v_exp_f32 v151, v119
    v_exp_f32 v152, v120
    v_exp_f32 v153, v121
    v_mfma_f32_32x32x16_bf16 v[132:147], v[104:107], v[84:87], v[132:147]
    v_exp_f32 v154, v122
    v_exp_f32 v155, v123
    v_exp_f32 v156, v124
    v_mfma_f32_32x32x16_bf16 v[132:147], v[108:111], v[88:91], v[132:147]
    v_exp_f32 v157, v125
    v_exp_f32 v158, v126
    v_exp_f32 v159, v127
    v_mfma_f32_32x32x16_bf16 v[132:147], v[112:115], v[92:95], v[132:147]
    v_exp_f32 v160, v128
    v_exp_f32 v161, v129
    v_exp_f32 v162, v130
    v_exp_f32 v163, v131
    v_pk_fma_f32 v[148:149], v[148:149], s[40:41], s[40:41]
    s_waitcnt vmcnt(1)
    ds_read_b128 v[96:99], v234
    v_pk_fma_f32 v[150:151], v[150:151], s[40:41], s[40:41]
    ds_read_b128 v[100:103], v234 offset:32
    v_pk_fma_f32 v[152:153], v[152:153], s[40:41], s[40:41]
    ds_read_b128 v[104:107], v235 offset:64
    v_pk_fma_f32 v[154:155], v[154:155], s[40:41], s[40:41]
    v_pk_fma_f32 v[156:157], v[156:157], s[40:41], s[40:41]
    ds_read_b128 v[108:111], v235 offset:96
    v_pk_fma_f32 v[158:159], v[158:159], s[40:41], s[40:41]
    ds_read_b128 v[112:115], v236
    v_pk_fma_f32 v[160:161], v[160:161], s[40:41], s[40:41]
    v_pk_fma_f32 v[162:163], v[162:163], s[40:41], s[40:41]
    v_rcp_f32 v148, v148
    s_waitcnt lgkmcnt(5)
    v_mfma_f32_32x32x16_bf16 v[132:147], v[200:203], v[204:207], v[132:147]
    v_rcp_f32 v149, v149
    v_rcp_f32 v150, v150
    v_rcp_f32 v151, v151
    v_rcp_f32 v152, v152
    v_rcp_f32 v153, v153
    v_rcp_f32 v154, v154
    v_rcp_f32 v155, v155
    v_rcp_f32 v156, v156
    v_rcp_f32 v157, v157
    v_rcp_f32 v158, v158
    v_rcp_f32 v159, v159
    v_rcp_f32 v160, v160
    v_rcp_f32 v161, v161
    v_rcp_f32 v162, v162
    v_rcp_f32 v163, v163
    v_pk_mul_f32 v[172:173], v[116:117], v[148:149]
    v_pk_mul_f32 v[174:175], v[120:121], v[152:153]
    v_pk_mul_f32 v[176:177], v[124:125], v[156:157]
    v_pk_mul_f32 v[178:179], v[128:129], v[160:161]
    v_pk_fma_f32 v[172:173], v[118:119], v[150:151], v[172:173]
    v_pk_fma_f32 v[174:175], v[122:123], v[154:155], v[174:175]
    v_pk_fma_f32 v[176:177], v[126:127], v[158:159], v[176:177]
    v_pk_fma_f32 v[178:179], v[130:131], v[162:163], v[178:179]
    ds_write_b64 v213, v[184:185] offset:512
    v_pk_fma_f32 v[184:185], v[184:185], v[212:213], v[172:173] op_sel_hi:[1,0,1]
    ds_write_b64 v215, v[184:185] offset:512
    v_pk_fma_f32 v[184:185], v[184:185], v[214:215], v[174:175] op_sel_hi:[1,0,1]
    ds_write_b64 v217, v[184:185] offset:512
    v_pk_fma_f32 v[184:185], v[184:185], v[216:217], v[176:177] op_sel_hi:[1,0,1]
    ds_write_b64 v219, v[184:185] offset:512
    v_pk_fma_f32 v[184:185], v[184:185], v[218:219], v[178:179] op_sel_hi:[1,0,1]
    s_setprio 0
    s_waitcnt lgkmcnt(0)
    v_mfma_f32_32x32x16_bf16 v[116:131], v[96:99], v[16:19], 0
    buffer_load_dwordx4 v220, s[4:7], s83 offen lds
    v_exp_f32 v148, v132
    v_exp_f32 v149, v133
    v_exp_f32 v150, v134
    v_mfma_f32_32x32x16_bf16 v[116:131], v[100:103], v[20:23], v[116:131]
    v_exp_f32 v151, v135
    v_exp_f32 v152, v136
    buffer_load_dwordx4 v221, s[4:7], s84 offen offset:1040 lds
    v_exp_f32 v153, v137
    v_mfma_f32_32x32x16_bf16 v[116:131], v[104:107], v[24:27], v[116:131]
    v_exp_f32 v154, v138
    v_exp_f32 v155, v139
    v_exp_f32 v156, v140
    v_mfma_f32_32x32x16_bf16 v[116:131], v[108:111], v[28:31], v[116:131]
    v_exp_f32 v157, v141
    buffer_load_dwordx4 v222, s[4:7], s85 offen offset:2080 lds
    v_exp_f32 v158, v142
    v_exp_f32 v159, v143
    v_mfma_f32_32x32x16_bf16 v[116:131], v[112:115], v[32:35], v[116:131]
    v_exp_f32 v160, v144
    v_exp_f32 v161, v145
    v_exp_f32 v162, v146
    v_exp_f32 v163, v147
    v_pk_fma_f32 v[148:149], v[148:149], s[40:41], s[40:41]
    buffer_load_dwordx4 v223, s[4:7], 0 offen offset:3120 lds
    v_pk_fma_f32 v[150:151], v[150:151], s[40:41], s[40:41]
    v_pk_fma_f32 v[152:153], v[152:153], s[40:41], s[40:41]
    v_pk_fma_f32 v[154:155], v[154:155], s[40:41], s[40:41]
    s_mov_b32 m0, s88
    s_xor_b32 s88, s88, 1024
    buffer_load_dwordx4 v224, s[8:11], 0 offen nt lds
    s_mov_b32 m0, s86
    v_pk_fma_f32 v[156:157], v[156:157], s[40:41], s[40:41]
    v_pk_fma_f32 v[158:159], v[158:159], s[40:41], s[40:41]
    v_pk_fma_f32 v[160:161], v[160:161], s[40:41], s[40:41]
    v_pk_fma_f32 v[162:163], v[162:163], s[40:41], s[40:41]
    v_rcp_f32 v148, v148
    v_rcp_f32 v149, v149
    v_xor_b32 v236, 1024, v236
    v_rcp_f32 v150, v150
    v_rcp_f32 v151, v151
    v_rcp_f32 v152, v152
    v_rcp_f32 v153, v153
    v_rcp_f32 v154, v154
    v_rcp_f32 v155, v155
    v_rcp_f32 v156, v156
    v_rcp_f32 v157, v157
    v_rcp_f32 v158, v158
    v_rcp_f32 v159, v159
    v_rcp_f32 v160, v160
    v_rcp_f32 v161, v161
    v_rcp_f32 v162, v162
    v_rcp_f32 v163, v163
    v_pk_mul_f32 v[172:173], v[132:133], v[148:149]
    v_pk_mul_f32 v[174:175], v[136:137], v[152:153]
    v_pk_mul_f32 v[176:177], v[140:141], v[156:157]
    v_pk_mul_f32 v[178:179], v[144:145], v[160:161]
    v_pk_fma_f32 v[172:173], v[134:135], v[150:151], v[172:173]
    v_pk_fma_f32 v[174:175], v[138:139], v[154:155], v[174:175]
    v_pk_fma_f32 v[176:177], v[142:143], v[158:159], v[176:177]
    v_pk_fma_f32 v[178:179], v[146:147], v[162:163], v[178:179]
    ds_write_b64 v213, v[186:187] offset:768
    v_pk_fma_f32 v[186:187], v[186:187], v[212:213], v[172:173] op_sel_hi:[1,0,1]
    ds_write_b64 v215, v[186:187] offset:768
    v_pk_fma_f32 v[186:187], v[186:187], v[214:215], v[174:175] op_sel_hi:[1,0,1]
    ds_write_b64 v217, v[186:187] offset:768
    v_pk_fma_f32 v[186:187], v[186:187], v[216:217], v[176:177] op_sel_hi:[1,0,1]
    ds_write_b64 v219, v[186:187] offset:768
    v_pk_fma_f32 v[186:187], v[186:187], v[218:219], v[178:179] op_sel_hi:[1,0,1]
    s_sub_u32 s82, s82, 1
    s_cbranch_scc1 L_fin_safe
    s_branch L_S_safe
L_fin_safe:
    ds_write_b64 v240, v[180:181] offset:0
    ds_write_b64 v240, v[182:183] offset:256
    ds_write_b64 v240, v[184:185] offset:512
    ds_write_b64 v240, v[186:187] offset:768
    s_cmp_lt_u32 s42, 4
    s_cbranch_scc0 L_mdone
    s_branch L_lateprep
L_mnone_c:
    s_bitcmp1_b32 s47, 1
    s_cbranch_scc1 k_wdone_n
    s_or_b32 s47, s47, 2
    v_lshlrev_b32 v14, 4, v1
    v_add_u32 v14, 103424, v14
    ds_read_b128 v[16:19], v14 offset:0
    ds_read_b128 v[20:23], v14 offset:1024
    ds_read_b128 v[24:27], v14 offset:2048
    ds_read_b128 v[28:31], v14 offset:3072
    ds_read_b128 v[32:35], v14 offset:4096
    ds_read_b128 v[36:39], v14 offset:5120
    ds_read_b128 v[40:43], v14 offset:6144
    ds_read_b128 v[44:47], v14 offset:7168
    ds_read_b128 v[48:51], v14 offset:8192
    ds_read_b128 v[52:55], v14 offset:9216
    ds_read_b128 v[56:59], v14 offset:10240
    ds_read_b128 v[60:63], v14 offset:11264
    ds_read_b128 v[64:67], v14 offset:12288
    ds_read_b128 v[68:71], v14 offset:13312
    ds_read_b128 v[72:75], v14 offset:14336
    ds_read_b128 v[76:79], v14 offset:15360
    ds_read_b128 v[80:83], v14 offset:16384
    ds_read_b128 v[84:87], v14 offset:17408
    ds_read_b128 v[88:91], v14 offset:18432
    ds_read_b128 v[92:95], v14 offset:19456
    s_waitcnt lgkmcnt(0)
    s_barrier
k_wdone_n:
L_lateprep:
    v_lshlrev_b32 v241, 2, v1
    ds_read_b32 v2, v241 offset:832
    ds_read_b32 v12, v241 offset:836
    ds_read_b32 v13, v241 offset:0
    v_lshlrev_b32 v14, 3, v1
    s_lshl_b32 s93, s42, 9
    s_add_u32 s93, s93, 31040
    v_add_u32 v14, s93, v14
    ds_read_b64 v[148:149], v14 offset:0
    ds_read_b64 v[150:151], v14 offset:4096
    ds_read_b64 v[152:153], v14 offset:8192
    ds_read_b64 v[154:155], v14 offset:12288
    ds_read_b64 v[156:157], v14 offset:16384
    s_lshr_b32 s90, s45, 3
    s_and_b32 s91, s45, 7
    v_lshrrev_b32 v3, 1, v1
    v_and_b32 v4, 1, v1
    v_cmp_gt_u32 vcc, s91, v3
    v_mul_u32_u24 v6, s90, v3
    v_min_u32 v7, s91, v3
    v_cndmask_b32_e64 v5, 0, 1, vcc
    v_add_u32 v5, s90, v5
    v_add_u32 v6, v6, v7
    v_lshlrev_b32 v6, 3, v6
    v_lshlrev_b32 v5, 2, v5
    v_mul_u32_u24 v7, v5, v4
    v_add_u32 v6, v6, v7
    v_add_u32 v7, v6, v5
    v_cmp_gt_u32 vcc, 16, v1
    v_mov_b32 v15, 0x7fffffff
    s_mov_b32 s99, 0xffff0000
    v_cndmask_b32 v6, v15, v6, vcc
    s_waitcnt lgkmcnt(0)
    v_sub_u32 v12, v12, v2
    v_sub_u32 v12, v12, v13
    v_cvt_f32_u32 v12, v12
    v_lshlrev_b32 v164, 16, v148
    v_and_b32 v172, s99, v148
    v_add_f32 v164, v164, v172
    v_lshlrev_b32 v165, 16, v149
    v_and_b32 v173, s99, v149
    v_add_f32 v165, v165, v173
    v_lshlrev_b32 v166, 16, v150
    v_and_b32 v174, s99, v150
    v_add_f32 v166, v166, v174
    v_lshlrev_b32 v167, 16, v151
    v_and_b32 v175, s99, v151
    v_add_f32 v167, v167, v175
    v_lshlrev_b32 v168, 16, v152
    v_and_b32 v176, s99, v152
    v_add_f32 v168, v168, v176
    v_lshlrev_b32 v169, 16, v153
    v_and_b32 v177, s99, v153
    v_add_f32 v169, v169, v177
    v_lshlrev_b32 v170, 16, v154
    v_and_b32 v178, s99, v154
    v_add_f32 v170, v170, v178
    v_lshlrev_b32 v171, 16, v155
    v_and_b32 v179, s99, v155
    v_add_f32 v171, v171, v179
    v_lshlrev_b32 v204, 16, v156
    v_and_b32 v180, s99, v156
    v_add_f32 v204, v204, v180
    v_lshlrev_b32 v205, 16, v157
    v_and_b32 v181, s99, v157
    v_add_f32 v205, v205, v181
    v_exp_f32 v172, v164
    v_exp_f32 v173, v165
    v_exp_f32 v174, v166
    v_exp_f32 v175, v167
    v_exp_f32 v176, v168
    v_exp_f32 v177, v169
    v_exp_f32 v178, v170
    v_exp_f32 v179, v171
    v_exp_f32 v180, v204
    v_exp_f32 v181, v205
    s_add_u32 s92, s42, 0
    s_add_u32 s93, s92, 1
    v_readlane_b32 s94, v2, s92
    v_readlane_b32 s95, v2, s93
    v_readlane_b32 s48, v12, s92
    v_fma_f32 v172, v172, s40, s40
    v_fma_f32 v173, v173, s40, s40
    s_lshr_b32 s94, s94, 2
    s_lshr_b32 s95, s95, 2
    v_rcp_f32 v172, v172
    v_rcp_f32 v173, v173
    v_cmp_gt_u32 vcc, s95, v6
    v_cmp_lt_u32 s[96:97], s94, v7
    v_mul_f32 v172, v164, v172
    v_mul_f32 v173, v165, v173
    s_and_b64 vcc, vcc, s[96:97]
    v_fma_f32 v244, -v172, s48, v244
    v_fma_f32 v245, -v173, s48, v245
    s_cmp_lt_u32 s94, s95
    s_cselect_b32 s58, vcc_lo, 0
    s_ff1_i32_b32 s94, s58
    s_add_u32 s95, s94, s92
    s_cmp_eq_u32 s58, 0
    s_cselect_b32 s95, 57, s95
    s_lshl_b32 s48, s95, 10
    s_add_u32 s94, s58, -1
    s_and_b32 s58, s58, s94
    s_ff1_i32_b32 s94, s58
    s_add_u32 s95, s94, s92
    s_cmp_eq_u32 s58, 0
    s_cselect_b32 s95, 57, s95
    s_lshl_b32 s53, s95, 10
    s_add_u32 s94, s58, -1
    s_and_b32 s58, s58, s94
    s_add_u32 s92, s42, 8
    s_add_u32 s93, s92, 1
    v_readlane_b32 s94, v2, s92
    v_readlane_b32 s95, v2, s93
    v_readlane_b32 s49, v12, s92
    v_fma_f32 v174, v174, s40, s40
    v_fma_f32 v175, v175, s40, s40
    s_lshr_b32 s94, s94, 2
    s_lshr_b32 s95, s95, 2
    v_rcp_f32 v174, v174
    v_rcp_f32 v175, v175
    v_cmp_gt_u32 vcc, s95, v6
    v_cmp_lt_u32 s[96:97], s94, v7
    v_mul_f32 v174, v166, v174
    v_mul_f32 v175, v167, v175
    s_and_b64 vcc, vcc, s[96:97]
    v_fma_f32 v246, -v174, s49, v246
    v_fma_f32 v247, -v175, s49, v247
    s_cmp_lt_u32 s94, s95
    s_cselect_b32 s59, vcc_lo, 0
    s_ff1_i32_b32 s94, s59
    s_add_u32 s95, s94, s92
    s_cmp_eq_u32 s59, 0
    s_cselect_b32 s95, 57, s95
    s_lshl_b32 s49, s95, 10
    s_add_u32 s94, s59, -1
    s_and_b32 s59, s59, s94
    s_ff1_i32_b32 s94, s59
    s_add_u32 s95, s94, s92
    s_cmp_eq_u32 s59, 0
    s_cselect_b32 s95, 57, s95
    s_lshl_b32 s54, s95, 10
    s_add_u32 s94, s59, -1
    s_and_b32 s59, s59, s94
    s_add_u32 s92, s42, 16
    s_add_u32 s93, s92, 1
    v_readlane_b32 s94, v2, s92
    v_readlane_b32 s95, v2, s93
    v_readlane_b32 s50, v12, s92
    v_fma_f32 v176, v176, s40, s40
    v_fma_f32 v177, v177, s40, s40
    s_lshr_b32 s94, s94, 2
    s_lshr_b32 s95, s95, 2
    v_rcp_f32 v176, v176
    v_rcp_f32 v177, v177
    v_cmp_gt_u32 vcc, s95, v6
    v_cmp_lt_u32 s[96:97], s94, v7
    v_mul_f32 v176, v168, v176
    v_mul_f32 v177, v169, v177
    s_and_b64 vcc, vcc, s[96:97]
    v_fma_f32 v248, -v176, s50, v248
    v_fma_f32 v249, -v177, s50, v249
    s_cmp_lt_u32 s94, s95
    s_cselect_b32 s60, vcc_lo, 0
    s_ff1_i32_b32 s94, s60
    s_add_u32 s95, s94, s92
    s_cmp_eq_u32 s60, 0
    s_cselect_b32 s95, 57, s95
    s_lshl_b32 s50, s95, 10
    s_add_u32 s94, s60, -1
    s_and_b32 s60, s60, s94
    s_ff1_i32_b32 s94, s60
    s_add_u32 s95, s94, s92
    s_cmp_eq_u32 s60, 0
    s_cselect_b32 s95, 57, s95
    s_lshl_b32 s55, s95, 10
    s_add_u32 s94, s60, -1
    s_and_b32 s60, s60, s94
    s_add_u32 s92, s42, 24
    s_add_u32 s93, s92, 1
    v_readlane_b32 s94, v2, s92
    v_readlane_b32 s95, v2, s93
    v_readlane_b32 s51, v12, s92
    v_fma_f32 v178, v178, s40, s40
    v_fma_f32 v179, v179, s40, s40
    s_lshr_b32 s94, s94, 2
    s_lshr_b32 s95, s95, 2
    v_rcp_f32 v178, v178
    v_rcp_f32 v179, v179
    v_cmp_gt_u32 vcc, s95, v6
    v_cmp_lt_u32 s[96:97], s94, v7
    v_mul_f32 v178, v170, v178
    v_mul_f32 v179, v171, v179
    s_and_b64 vcc, vcc, s[96:97]
    v_fma_f32 v250, -v178, s51, v250
    v_fma_f32 v251, -v179, s51, v251
    s_cmp_lt_u32 s94, s95
    s_cselect_b32 s61, vcc_lo, 0
    s_ff1_i32_b32 s94, s61
    s_add_u32 s95, s94, s92
    s_cmp_eq_u32 s61, 0
    s_cselect_b32 s95, 57, s95
    s_lshl_b32 s51, s95, 10
    s_add_u32 s94, s61, -1
    s_and_b32 s61, s61, s94
    s_ff1_i32_b32 s94, s61
    s_add_u32 s95, s94, s92
    s_cmp_eq_u32 s61, 0
    s_cselect_b32 s95, 57, s95
    s_lshl_b32 s56, s95, 10
    s_add_u32 s94, s61, -1
    s_and_b32 s61, s61, s94
    s_add_u32 s92, s42, 32
    s_add_u32 s93, s92, 1
    v_readlane_b32 s94, v2, s92
    v_readlane_b32 s95, v2, s93
    v_readlane_b32 s52, v12, s92
    v_fma_f32 v180, v180, s40, s40
    v_fma_f32 v181, v181, s40, s40
    s_lshr_b32 s94, s94, 2
    s_lshr_b32 s95, s95, 2
    v_rcp_f32 v180, v180
    v_rcp_f32 v181, v181
    v_cmp_gt_u32 vcc, s95, v6
    v_cmp_lt_u32 s[96:97], s94, v7
    v_mul_f32 v180, v204, v180
    v_mul_f32 v181, v205, v181
    s_and_b64 vcc, vcc, s[96:97]
    v_fma_f32 v252, -v180, s52, v252
    v_fma_f32 v253, -v181, s52, v253
    s_cmp_lt_u32 s94, s95
    s_cselect_b32 s62, vcc_lo, 0
    s_ff1_i32_b32 s94, s62
    s_add_u32 s95, s94, s92
    s_cmp_eq_u32 s62, 0
    s_cselect_b32 s95, 57, s95
    s_lshl_b32 s52, s95, 10
    s_add_u32 s94, s62, -1
    s_and_b32 s62, s62, s94
    s_ff1_i32_b32 s94, s62
    s_add_u32 s95, s94, s92
    s_cmp_eq_u32 s62, 0
    s_cselect_b32 s95, 57, s95
    s_lshl_b32 s57, s95, 10
    s_add_u32 s94, s62, -1
    s_and_b32 s62, s62, s94
L_mdone:
k_mjoin:
    s_waitcnt vmcnt(0) lgkmcnt(0)
    s_cmp_ge_u32 s42, 4
    s_cbranch_scc1 k_now2
    s_and_b32 s90, s42, 1
    s_lshl_b32 s91, s90, 13
    s_add_u32 s91, s91, 20480
    s_add_u32 s92, s91, 4096
    v_lshlrev_b32 v14, 4, v1
    buffer_load_dwordx4 v[116:119], v14, s[16:19], s91 offen offset:0 sc1
    buffer_load_dwordx4 v[120:123], v14, s[16:19], s91 offen offset:1024 sc1
    buffer_load_dwordx4 v[124:127], v14, s[16:19], s91 offen offset:2048 sc1
    buffer_load_dwordx4 v[128:131], v14, s[16:19], s91 offen offset:3072 sc1
    buffer_load_dwordx4 v[132:135], v14, s[16:19], s92 offen offset:0 sc1
    buffer_load_dwordx4 v[136:139], v14, s[16:19], s92 offen offset:1024 sc1
    buffer_load_dwordx4 v[140:143], v14, s[16:19], s92 offen offset:2048 sc1
    buffer_load_dwordx4 v[144:147], v14, s[16:19], s92 offen offset:3072 sc1
    v_lshrrev_b32 v5, 5, v1
    s_lshl_b32 s93, s90, 6
    v_lshl_add_u32 v13, v5, 3, s93
    buffer_load_dwordx2 v[212:213], v13, s[28:31], 0 offen offset:0
    buffer_load_dwordx2 v[214:215], v13, s[28:31], 0 offen offset:16
    buffer_load_dwordx2 v[216:217], v13, s[28:31], 0 offen offset:32
    buffer_load_dwordx2 v[218:219], v13, s[28:31], 0 offen offset:48
k_now2:
    v_lshlrev_b32 v9, 4, v1
    v_add_u32 v9, 102400, v9
    v_add_u32 v96, s48, v9
    v_add_u32 v97, s53, v9
    v_add_u32 v98, s49, v9
    v_add_u32 v99, s54, v9
    v_add_u32 v100, s50, v9
    v_add_u32 v101, s55, v9
    v_add_u32 v102, s51, v9
    v_add_u32 v103, s56, v9
    v_add_u32 v104, s52, v9
    v_add_u32 v105, s57, v9
    s_barrier
    ds_read_b128 v[148:151], v96
    ds_read_b128 v[152:155], v97
    ds_read_b128 v[156:159], v98
    ds_read_b128 v[160:163], v99
    ds_read_b128 v[164:167], v100
    ds_read_b128 v[168:171], v101
    ds_read_b128 v[172:175], v102
    ds_read_b128 v[176:179], v103
    ds_read_b128 v[180:183], v104
    ds_read_b128 v[184:187], v105
    s_waitcnt lgkmcnt(8)
    v_add_f32 v148, v148, v149
    v_add_f32 v152, v152, v153
    v_add_f32 v244, v244, v148
    v_add_f32 v244, v244, v152
    v_add_f32 v150, v150, v151
    v_add_f32 v154, v154, v155
    v_add_f32 v245, v245, v150
    v_add_f32 v245, v245, v154
    s_waitcnt lgkmcnt(6)
    v_add_f32 v156, v156, v157
    v_add_f32 v160, v160, v161
    v_add_f32 v246, v246, v156
    v_add_f32 v246, v246, v160
    v_add_f32 v158, v158, v159
    v_add_f32 v162, v162, v163
    v_add_f32 v247, v247, v158
    v_add_f32 v247, v247, v162
    s_waitcnt lgkmcnt(4)
    v_add_f32 v164, v164, v165
    v_add_f32 v168, v168, v169
    v_add_f32 v248, v248, v164
    v_add_f32 v248, v248, v168
    v_add_f32 v166, v166, v167
    v_add_f32 v170, v170, v171
    v_add_f32 v249, v249, v166
    v_add_f32 v249, v249, v170
    s_waitcnt lgkmcnt(2)
    v_add_f32 v172, v172, v173
    v_add_f32 v176, v176, v177
    v_add_f32 v250, v250, v172
    v_add_f32 v250, v250, v176
    v_add_f32 v174, v174, v175
    v_add_f32 v178, v178, v179
    v_add_f32 v251, v251, v174
    v_add_f32 v251, v251, v178
    s_waitcnt lgkmcnt(0)
    v_add_f32 v180, v180, v181
    v_add_f32 v184, v184, v185
    v_add_f32 v252, v252, v180
    v_add_f32 v252, v252, v184
    v_add_f32 v182, v182, v183
    v_add_f32 v186, v186, v187
    v_add_f32 v253, v253, v182
    v_add_f32 v253, v253, v186
k_more_0:
    s_cmp_eq_u32 s58, 0
    s_cbranch_scc1 k_moredone_0
    s_ff1_i32_b32 s94, s58
    s_add_u32 s95, s94, s42
    s_add_u32 s95, s95, 0
    s_lshl_b32 s95, s95, 10
    v_add_u32 v10, s95, v9
    ds_read_b128 v[148:151], v10
    s_add_u32 s94, s58, -1
    s_and_b32 s58, s58, s94
    s_waitcnt lgkmcnt(0)
    v_add_f32 v148, v148, v149
    v_add_f32 v244, v244, v148
    v_add_f32 v150, v150, v151
    v_add_f32 v245, v245, v150
    s_branch k_more_0
k_moredone_0:
k_more_1:
    s_cmp_eq_u32 s59, 0
    s_cbranch_scc1 k_moredone_1
    s_ff1_i32_b32 s94, s59
    s_add_u32 s95, s94, s42
    s_add_u32 s95, s95, 8
    s_lshl_b32 s95, s95, 10
    v_add_u32 v10, s95, v9
    ds_read_b128 v[148:151], v10
    s_add_u32 s94, s59, -1
    s_and_b32 s59, s59, s94
    s_waitcnt lgkmcnt(0)
    v_add_f32 v148, v148, v149
    v_add_f32 v246, v246, v148
    v_add_f32 v150, v150, v151
    v_add_f32 v247, v247, v150
    s_branch k_more_1
k_moredone_1:
k_more_2:
    s_cmp_eq_u32 s60, 0
    s_cbranch_scc1 k_moredone_2
    s_ff1_i32_b32 s94, s60
    s_add_u32 s95, s94, s42
    s_add_u32 s95, s95, 16
    s_lshl_b32 s95, s95, 10
    v_add_u32 v10, s95, v9
    ds_read_b128 v[148:151], v10
    s_add_u32 s94, s60, -1
    s_and_b32 s60, s60, s94
    s_waitcnt lgkmcnt(0)
    v_add_f32 v148, v148, v149
    v_add_f32 v248, v248, v148
    v_add_f32 v150, v150, v151
    v_add_f32 v249, v249, v150
    s_branch k_more_2
k_moredone_2:
k_more_3:
    s_cmp_eq_u32 s61, 0
    s_cbranch_scc1 k_moredone_3
    s_ff1_i32_b32 s94, s61
    s_add_u32 s95, s94, s42
    s_add_u32 s95, s95, 24
    s_lshl_b32 s95, s95, 10
    v_add_u32 v10, s95, v9
    ds_read_b128 v[148:151], v10
    s_add_u32 s94, s61, -1
    s_and_b32 s61, s61, s94
    s_waitcnt lgkmcnt(0)
    v_add_f32 v148, v148, v149
    v_add_f32 v250, v250, v148
    v_add_f32 v150, v150, v151
    v_add_f32 v251, v251, v150
    s_branch k_more_3
k_moredone_3:
k_more_4:
    s_cmp_eq_u32 s62, 0
    s_cbranch_scc1 k_moredone_4
    s_ff1_i32_b32 s94, s62
    s_add_u32 s95, s94, s42
    s_add_u32 s95, s95, 32
    s_lshl_b32 s95, s95, 10
    v_add_u32 v10, s95, v9
    ds_read_b128 v[148:151], v10
    s_add_u32 s94, s62, -1
    s_and_b32 s62, s62, s94
    s_waitcnt lgkmcnt(0)
    v_add_f32 v148, v148, v149
    v_add_f32 v252, v252, v148
    v_add_f32 v150, v150, v151
    v_add_f32 v253, v253, v150
    s_branch k_more_4
k_moredone_4:
    s_bitcmp1_b32 s47, 0
    s_cbranch_scc0 k_epi
    s_waitcnt vmcnt(0)
    s_barrier
    s_add_u32 s81, s81, 2048
    s_cmp_lt_u32 s81, 640000
    s_cbranch_scc1 k_slowfetch
    s_branch k_epi
k_goslow:
    s_or_b32 s47, s47, 1
    s_mov_b32 s80, 1
    s_mov_b32 s81, 0
    s_waitcnt lgkmcnt(0)
    s_barrier
k_slowfetch:
    s_lshl_b32 s90, s81, 2
    v_lshlrev_b32 v242, 4, v0
    v_add_u32 v242, s90, v242
    buffer_load_dwordx4 v[96:99], v242, s[36:39], 0 offen
    buffer_load_dwordx4 v[100:103], v242, s[32:35], 0 offen
    v_lshlrev_b32 v241, 4, v0
    v_mov_b32 v212, 0x7fffff00
    v_mov_b32 v213, 0x7fffff00
    v_mov_b32 v214, 0x7fffff00
    v_mov_b32 v215, 0x7fffff00
    ds_write_b128 v241, v[212:215] offset:1088
    ds_write_b128 v241, v[212:215] offset:9280
    ds_write_b128 v241, v[212:215] offset:17472
    v_cmp_gt_u32 vcc, 128, v0
    s_and_saveexec_b64 s[98:99], vcc
    ds_write_b128 v241, v[212:215] offset:25664
    s_mov_b64 exec, s[98:99]
    v_mov_b32 v216, 20480
    v_mov_b32 v217, 20480
    v_mov_b32 v218, 20480
    v_mov_b32 v219, 20480
    v_cmp_gt_u32 vcc, 208, v0
    s_and_saveexec_b64 s[98:99], vcc
    ds_write_b128 v241, v[216:219] offset:27712
    s_mov_b64 exec, s[98:99]
    v_mov_b32 v164, 0
    v_mov_b32 v165, 0
    v_mov_b32 v166, 0
    v_mov_b32 v167, 0
    v_cmp_gt_u32 vcc, 16, v0
    s_and_saveexec_b64 s[98:99], vcc
    ds_write_b128 v241, v[164:167] offset:0
    s_mov_b64 exec, s[98:99]
    v_lshlrev_b32 v208, 2, v0
    v_add_u32 v208, s81, v208
    s_mov_b32 s90, 109951163
    s_mov_b32 s91, 640000
    s_waitcnt vmcnt(0)
    v_mul_hi_u32 v104, v96, s90
    v_subrev_u32 v96, s43, v96
    v_lshlrev_b32 v96, 26, v96
    v_or_b32 v116, v96, v100
    v_mul_hi_u32 v105, v97, s90
    v_subrev_u32 v97, s43, v97
    v_lshlrev_b32 v97, 26, v97
    v_or_b32 v117, v97, v101
    v_or_b32 v117, 16384, v117
    v_mul_hi_u32 v106, v98, s90
    v_subrev_u32 v98, s43, v98
    v_lshlrev_b32 v98, 26, v98
    v_or_b32 v118, v98, v102
    v_or_b32 v118, 32768, v118
    v_mul_hi_u32 v107, v99, s90
    v_subrev_u32 v99, s43, v99
    v_lshlrev_b32 v99, 26, v99
    v_or_b32 v119, v99, v103
    v_or_b32 v119, 49152, v119
    v_cmp_gt_u32 vcc, s91, v208
    v_cmp_eq_u32 s[48:49], s2, v104
    s_and_b64 s[48:49], s[48:49], vcc
    v_cmp_eq_u32 s[50:51], s2, v105
    s_and_b64 s[50:51], s[50:51], vcc
    v_cmp_eq_u32 s[52:53], s2, v106
    s_and_b64 s[52:53], s[52:53], vcc
    v_cmp_eq_u32 s[54:55], s2, v107
    s_and_b64 s[54:55], s[54:55], vcc
    s_mov_b64 s[56:57], 0
    s_mov_b64 s[58:59], 0
    s_mov_b64 s[60:61], 0
    s_mov_b64 s[62:63], 0
    s_mov_b64 s[64:65], 0
    s_mov_b64 s[66:67], 0
    s_mov_b64 s[68:69], 0
    s_mov_b64 s[70:71], 0
    s_mov_b64 s[72:73], 0
    s_mov_b64 s[74:75], 0
    s_mov_b64 s[76:77], 0
    s_mov_b64 s[78:79], 0
    s_waitcnt lgkmcnt(0)
    s_barrier
    v_mov_b32 v242, 1
    v_lshrrev_b32 v132, 26, v116
    v_lshlrev_b32 v148, 2, v132
    v_lshrrev_b32 v133, 26, v117
    v_lshlrev_b32 v149, 2, v133
    v_lshrrev_b32 v134, 26, v118
    v_lshlrev_b32 v150, 2, v134
    v_lshrrev_b32 v135, 26, v119
    v_lshlrev_b32 v151, 2, v135
    v_lshrrev_b32 v136, 26, v120
    v_lshlrev_b32 v152, 2, v136
    v_lshrrev_b32 v137, 26, v121
    v_lshlrev_b32 v153, 2, v137
    v_lshrrev_b32 v138, 26, v122
    v_lshlrev_b32 v154, 2, v138
    v_lshrrev_b32 v139, 26, v123
    v_lshlrev_b32 v155, 2, v139
    s_mov_b64 exec, s[48:49]
    ds_add_rtn_u32 v148, v148, v242
    s_mov_b64 exec, s[50:51]
    ds_add_rtn_u32 v149, v149, v242
    s_mov_b64 exec, s[52:53]
    ds_add_rtn_u32 v150, v150, v242
    s_mov_b64 exec, s[54:55]
    ds_add_rtn_u32 v151, v151, v242
    s_mov_b64 exec, s[56:57]
    ds_add_rtn_u32 v152, v152, v242
    s_mov_b64 exec, s[58:59]
    ds_add_rtn_u32 v153, v153, v242
    s_mov_b64 exec, s[60:61]
    ds_add_rtn_u32 v154, v154, v242
    s_mov_b64 exec, s[62:63]
    ds_add_rtn_u32 v155, v155, v242
    s_waitcnt vmcnt(0)
    s_mov_b64 exec, s[64:65]
    s_cbranch_execz k_hskip_2_8
    v_lshrrev_b32 v140, 26, v124
    v_lshlrev_b32 v156, 2, v140
    ds_add_rtn_u32 v156, v156, v242
k_hskip_2_8:
    s_mov_b64 exec, s[66:67]
    s_cbranch_execz k_hskip_2_9
    v_lshrrev_b32 v141, 26, v125
    v_lshlrev_b32 v157, 2, v141
    ds_add_rtn_u32 v157, v157, v242
k_hskip_2_9:
    s_mov_b64 exec, s[68:69]
    s_cbranch_execz k_hskip_2_10
    v_lshrrev_b32 v142, 26, v126
    v_lshlrev_b32 v158, 2, v142
    ds_add_rtn_u32 v158, v158, v242
k_hskip_2_10:
    s_mov_b64 exec, s[70:71]
    s_cbranch_execz k_hskip_2_11
    v_lshrrev_b32 v143, 26, v127
    v_lshlrev_b32 v159, 2, v143
    ds_add_rtn_u32 v159, v159, v242
k_hskip_2_11:
    s_mov_b64 exec, s[72:73]
    s_cbranch_execz k_hskip_2_12
    v_lshrrev_b32 v144, 26, v128
    v_lshlrev_b32 v160, 2, v144
    ds_add_rtn_u32 v160, v160, v242
k_hskip_2_12:
    s_mov_b64 exec, s[74:75]
    s_cbranch_execz k_hskip_2_13
    v_lshrrev_b32 v145, 26, v129
    v_lshlrev_b32 v161, 2, v145
    ds_add_rtn_u32 v161, v161, v242
k_hskip_2_13:
    s_mov_b64 exec, s[76:77]
    s_cbranch_execz k_hskip_2_14
    v_lshrrev_b32 v146, 26, v130
    v_lshlrev_b32 v162, 2, v146
    ds_add_rtn_u32 v162, v162, v242
k_hskip_2_14:
    s_mov_b64 exec, s[78:79]
    s_cbranch_execz k_hskip_2_15
    v_lshrrev_b32 v147, 26, v131
    v_lshlrev_b32 v163, 2, v147
    ds_add_rtn_u32 v163, v163, v242
k_hskip_2_15:
    s_mov_b64 exec, -1
    s_waitcnt lgkmcnt(0)
    s_barrier
    s_branch k_scan
k_epi:
    s_mul_i32 s93, s42, 272
    s_add_u32 s93, s93, 52032
    v_lshl_add_u32 v4, v1, 2, s93
    s_mov_b32 s94, 0xb3317218
    s_mov_b32 s95, 0xffff0000
    v_mov_b32 v5, 0x207
    s_mov_b64 s[96:97], 0
    v_cmp_class_f32 vcc, v244, v5
    v_mul_f32 v96, s94, v244
    s_or_b64 s[96:97], s[96:97], vcc
    v_cmp_class_f32 vcc, v245, v5
    v_mul_f32 v97, s94, v245
    s_or_b64 s[96:97], s[96:97], vcc
    v_cmp_class_f32 vcc, v246, v5
    v_mul_f32 v98, s94, v246
    s_or_b64 s[96:97], s[96:97], vcc
    v_cmp_class_f32 vcc, v247, v5
    v_mul_f32 v99, s94, v247
    s_or_b64 s[96:97], s[96:97], vcc
    v_cmp_class_f32 vcc, v248, v5
    v_mul_f32 v100, s94, v248
    s_or_b64 s[96:97], s[96:97], vcc
    v_cmp_class_f32 vcc, v249, v5
    v_mul_f32 v101, s94, v249
    s_or_b64 s[96:97], s[96:97], vcc
    v_cmp_class_f32 vcc, v250, v5
    v_mul_f32 v102, s94, v250
    s_or_b64 s[96:97], s[96:97], vcc
    v_cmp_class_f32 vcc, v251, v5
    v_mul_f32 v103, s94, v251
    s_or_b64 s[96:97], s[96:97], vcc
    v_cmp_class_f32 vcc, v252, v5
    v_mul_f32 v104, s94, v252
    s_or_b64 s[96:97], s[96:97], vcc
    v_cmp_class_f32 vcc, v253, v5
    v_mul_f32 v105, s94, v253
    s_or_b64 s[96:97], s[96:97], vcc
    v_cvt_pk_bf16_f32 v148, v96, v97
    v_lshlrev_b32 v149, 16, v148
    v_and_b32 v150, s95, v148
    ds_write_b32 v4, v148 offset:0
    v_sub_f32 v149, v96, v149
    v_sub_f32 v150, v97, v150
    v_cvt_pk_bf16_f32 v151, v149, v150
    ds_write_b32 v4, v151 offset:10880
    v_cvt_pk_bf16_f32 v152, v98, v99
    v_lshlrev_b32 v153, 16, v152
    v_and_b32 v154, s95, v152
    ds_write_b32 v4, v152 offset:2176
    v_sub_f32 v153, v98, v153
    v_sub_f32 v154, v99, v154
    v_cvt_pk_bf16_f32 v155, v153, v154
    ds_write_b32 v4, v155 offset:13056
    v_cvt_pk_bf16_f32 v156, v100, v101
    v_lshlrev_b32 v157, 16, v156
    v_and_b32 v158, s95, v156
    ds_write_b32 v4, v156 offset:4352
    v_sub_f32 v157, v100, v157
    v_sub_f32 v158, v101, v158
    v_cvt_pk_bf16_f32 v159, v157, v158
    ds_write_b32 v4, v159 offset:15232
    v_cvt_pk_bf16_f32 v160, v102, v103
    v_lshlrev_b32 v161, 16, v160
    v_and_b32 v162, s95, v160
    ds_write_b32 v4, v160 offset:6528
    v_sub_f32 v161, v102, v161
    v_sub_f32 v162, v103, v162
    v_cvt_pk_bf16_f32 v163, v161, v162
    ds_write_b32 v4, v163 offset:17408
    v_cvt_pk_bf16_f32 v164, v104, v105
    v_lshlrev_b32 v165, 16, v164
    v_and_b32 v166, s95, v164
    ds_write_b32 v4, v164 offset:8704
    v_sub_f32 v165, v104, v165
    v_sub_f32 v166, v105, v166
    v_cvt_pk_bf16_f32 v167, v165, v166
    ds_write_b32 v4, v167 offset:19584
    s_cmp_eq_u64 s[96:97], 0
    s_cbranch_scc1 k_fin
    v_mov_b32 v241, 772
    v_mov_b32 v242, 1
    ds_write_b32 v241, v242
k_fin:
    s_waitcnt lgkmcnt(0)
    s_barrier
    v_mov_b32 v241, 772
    ds_read_b32 v242, v241
    s_lshr_b32 s91, s42, 1
    v_and_b32 v4, 31, v1
    v_lshrrev_b32 v5, 5, v1
    s_lshl_b32 s92, s91, 5
    v_add_u32 v6, s92, v4
    s_waitcnt lgkmcnt(0)
    v_readfirstlane_b32 s90, v242
    s_andn2_b32 s90, s90, s80
    s_cmp_lg_u32 s90, 0
    s_cbranch_scc0 k_final
    s_mov_b32 s80, 1
    s_waitcnt vmcnt(0)
    v_mov_b32 v244, 0
    v_mov_b32 v245, 0
    v_mov_b32 v246, 0
    v_mov_b32 v247, 0
    v_mov_b32 v248, 0
    v_mov_b32 v249, 0
    v_mov_b32 v250, 0
    v_mov_b32 v251, 0
    v_mov_b32 v252, 0
    v_mov_b32 v253, 0
    s_barrier
    s_branch k_main
k_final:
    s_cmp_ge_u32 s42, 4
    s_cbranch_scc1 k_end
    v_mul_u32_u24 v7, 272, v6
    v_lshl_add_u32 v7, v5, 4, v7
    v_add_u32 v7, 52032, v7
    v_lshlrev_b32 v8, 2, v6
    ds_read_b32 v9, v8 offset:256
    ds_read_b128 v[16:19], v7 offset:0
    ds_read_b128 v[20:23], v7 offset:10880
    ds_read_b128 v[24:27], v7 offset:32
    ds_read_b128 v[28:31], v7 offset:10912
    ds_read_b128 v[32:35], v7 offset:64
    ds_read_b128 v[36:39], v7 offset:10944
    ds_read_b128 v[40:43], v7 offset:96
    ds_read_b128 v[44:47], v7 offset:10976
    ds_read_b128 v[48:51], v7 offset:128
    ds_read_b128 v[52:55], v7 offset:11008
    ds_read_b128 v[56:59], v7 offset:160
    ds_read_b128 v[60:63], v7 offset:11040
    ds_read_b128 v[64:67], v7 offset:192
    ds_read_b128 v[68:71], v7 offset:11072
    s_mov_b32 s95, 0xffff0000
    s_waitcnt vmcnt(0)
    s_waitcnt lgkmcnt(13)
    v_mfma_f32_32x32x16_bf16 v[148:163], v[116:119], v[16:19], 0
    ds_read_b128 v[72:75], v7 offset:224
    s_waitcnt lgkmcnt(13)
    v_mfma_f32_32x32x16_bf16 v[148:163], v[116:119], v[20:23], v[148:163]
    ds_read_b128 v[76:79], v7 offset:11104
    v_lshlrev_b32 v96, 16, v212
    v_and_b32 v97, s95, v212
    s_waitcnt lgkmcnt(13)
    v_mfma_f32_32x32x16_bf16 v[148:163], v[120:123], v[24:27], v[148:163]
    s_waitcnt lgkmcnt(12)
    v_mfma_f32_32x32x16_bf16 v[148:163], v[120:123], v[28:31], v[148:163]
    v_lshlrev_b32 v98, 16, v213
    v_and_b32 v99, s95, v213
    s_waitcnt lgkmcnt(11)
    v_mfma_f32_32x32x16_bf16 v[148:163], v[124:127], v[32:35], v[148:163]
    s_waitcnt lgkmcnt(10)
    v_mfma_f32_32x32x16_bf16 v[148:163], v[124:127], v[36:39], v[148:163]
    v_lshlrev_b32 v100, 16, v214
    v_and_b32 v101, s95, v214
    s_waitcnt lgkmcnt(9)
    v_mfma_f32_32x32x16_bf16 v[148:163], v[128:131], v[40:43], v[148:163]
    s_waitcnt lgkmcnt(8)
    v_mfma_f32_32x32x16_bf16 v[148:163], v[128:131], v[44:47], v[148:163]
    v_lshlrev_b32 v102, 16, v215
    v_and_b32 v103, s95, v215
    s_waitcnt lgkmcnt(7)
    v_mfma_f32_32x32x16_bf16 v[148:163], v[132:135], v[48:51], v[148:163]
    s_waitcnt lgkmcnt(6)
    v_mfma_f32_32x32x16_bf16 v[148:163], v[132:135], v[52:55], v[148:163]
    v_lshlrev_b32 v104, 16, v216
    v_and_b32 v105, s95, v216
    s_waitcnt lgkmcnt(5)
    v_mfma_f32_32x32x16_bf16 v[148:163], v[136:139], v[56:59], v[148:163]
    s_waitcnt lgkmcnt(4)
    v_mfma_f32_32x32x16_bf16 v[148:163], v[136:139], v[60:63], v[148:163]
    v_lshlrev_b32 v106, 16, v217
    v_and_b32 v107, s95, v217
    s_waitcnt lgkmcnt(3)
    v_mfma_f32_32x32x16_bf16 v[148:163], v[140:143], v[64:67], v[148:163]
    s_waitcnt lgkmcnt(2)
    v_mfma_f32_32x32x16_bf16 v[148:163], v[140:143], v[68:71], v[148:163]
    v_lshlrev_b32 v108, 16, v218
    v_and_b32 v109, s95, v218
    s_waitcnt lgkmcnt(1)
    v_mfma_f32_32x32x16_bf16 v[148:163], v[144:147], v[72:75], v[148:163]
    s_waitcnt lgkmcnt(0)
    v_mfma_f32_32x32x16_bf16 v[148:163], v[144:147], v[76:79], v[148:163]
    v_lshlrev_b32 v110, 16, v219
    v_and_b32 v111, s95, v219
    v_cvt_f32_u32 v9, v9
    s_and_b32 s90, s42, 1
    s_lshl_b32 s90, s90, 6
    v_add_u32 v10, s43, v6
    v_lshlrev_b32 v10, 7, v10
    v_lshl_add_u32 v10, v5, 3, v10
    v_add_u32 v10, s90, v10
    v_cmp_gt_u32 vcc, s44, v6
    s_nop 7
    v_fma_f32 v148, v9, v96, v148
    v_fma_f32 v149, v9, v97, v149
    v_fma_f32 v150, v9, v98, v150
    v_fma_f32 v151, v9, v99, v151
    v_fma_f32 v152, v9, v100, v152
    v_fma_f32 v153, v9, v101, v153
    v_fma_f32 v154, v9, v102, v154
    v_fma_f32 v155, v9, v103, v155
    v_fma_f32 v156, v9, v104, v156
    v_fma_f32 v157, v9, v105, v157
    v_fma_f32 v158, v9, v106, v158
    v_fma_f32 v159, v9, v107, v159
    v_fma_f32 v160, v9, v108, v160
    v_fma_f32 v161, v9, v109, v161
    v_fma_f32 v162, v9, v110, v162
    v_fma_f32 v163, v9, v111, v163
    v_cvt_pk_bf16_f32 v164, v148, v149
    v_cvt_pk_bf16_f32 v165, v150, v151
    v_cvt_pk_bf16_f32 v166, v152, v153
    v_cvt_pk_bf16_f32 v167, v154, v155
    v_cvt_pk_bf16_f32 v168, v156, v157
    v_cvt_pk_bf16_f32 v169, v158, v159
    v_cvt_pk_bf16_f32 v170, v160, v161
    v_cvt_pk_bf16_f32 v171, v162, v163
    s_and_saveexec_b64 s[96:97], vcc
    s_cbranch_execz k_end
    buffer_store_dwordx2 v[164:165], v10, s[20:23], 0 offen offset:0
    buffer_store_dwordx2 v[166:167], v10, s[20:23], 0 offen offset:16
    buffer_store_dwordx2 v[168:169], v10, s[20:23], 0 offen offset:32
    buffer_store_dwordx2 v[170:171], v10, s[20:23], 0 offen offset:48
k_end:
    s_endpgm
.section .rodata,"a"
.p2align 6
.amdhsa_kernel gather_scatter__edge_featured_mpnn_mpnn__graph_kernel
  .amdhsa_next_free_vgpr 254
  .amdhsa_next_free_sgpr 102
  .amdhsa_accum_offset 256
  .amdhsa_group_segment_fixed_size 0
  .amdhsa_kernarg_size 88
  .amdhsa_user_sgpr_count 2
  .amdhsa_user_sgpr_kernarg_segment_ptr 1
  .amdhsa_system_sgpr_workgroup_id_x 1
  .amdhsa_float_denorm_mode_32 3
.end_amdhsa_kernel
```
